```python
import torch

def _softmax(x, axis=-1):
    return torch.softmax(x, dim=axis)
def _gelu(x):
    return torch.nn.functional.gelu(x, approximate="tanh")
def _silu(x):
    return torch.nn.functional.silu(x)
def _sigmoid(x):
    return torch.sigmoid(x)
def _layernorm(x, axis=-1, eps=1e-5):
    m = x.mean(dim=axis, keepdim=True)
    v = x.var(dim=axis, keepdim=True, unbiased=False)
    return (x - m) / torch.sqrt(v + eps)
def _scatter_add(tgt, idx, src, axis=0):
    return tgt.clone().index_add_(axis, idx, src)
def _segment_sum(src, seg, n):
    out = torch.zeros((n,) + src.shape[1:], dtype=src.dtype)
    return out.index_add_(0, seg, src)
def _pad(x, pw):
    flat = tuple(v for pair in reversed(pw) for v in pair)
    return torch.nn.functional.pad(x, flat)

kernel_name = 'parallel_sum__mha_block__mixer_token_mlp__prompt'

def setup_inputs():

    _w = (lambda a: (lambda t: t.to(torch.bfloat16) if t.is_floating_point() else t)(torch.as_tensor(a)))
    def _A_setup():
        B, S, D, H = 1, 2048, 640, 32
        return {
            "x": _w((lambda *s: torch.randn(*s, dtype=torch.bfloat16) * 0.05)(B, S, D)),
            "wqkv": _w((lambda *s: torch.randn(*s, dtype=torch.bfloat16) * 0.05)(D, 3 * D)),
            "wo": _w((lambda *s: torch.randn(*s, dtype=torch.bfloat16) * 0.05)(D, D)),
        }
    _A_in = _A_setup()

    def _B_setup():
        B, S, D, F = 1, 2048, 640, 1728
        return {
            "x": _w((lambda *s: torch.randn(*s, dtype=torch.bfloat16) * 0.05)(B, S, D)),
            "w1": _w((lambda *s: torch.randn(*s, dtype=torch.bfloat16) * 1.6)(S, F) * (S ** -0.5)),
            "b1": _w((lambda *s: torch.randn(*s, dtype=torch.bfloat16) * 12.8)(F) * 0.02),
            "w2": _w((lambda *s: torch.randn(*s, dtype=torch.bfloat16) * 0.8)(F, S) * (F ** -0.5)),
            "b2": _w((lambda *s: torch.randn(*s, dtype=torch.bfloat16) * 12.8)(S) * 0.02),
        }
    _B_in = _B_setup()

    return {
        "A_x": _A_in["x"],
        "A_wqkv": _A_in["wqkv"],
        "A_wo": _A_in["wo"],
        "B_x": _B_in["x"],
        "B_w1": _B_in["w1"],
        "B_b1": _B_in["b1"],
        "B_w2": _B_in["w2"],
        "B_b2": _B_in["b2"],
    }

def reference(A_x, A_wqkv, A_wo, B_x, B_w1, B_b1, B_w2, B_b2):
    def _A_ref(x, wqkv, wo):
        B, S, D = x.shape
        H = 32
        Dh = D // H
        qkv = (lambda x, *d: x.permute(*d))((x @ wqkv).reshape(B, S, 3, H, Dh), 2, 0, 3, 1, 4)
        q, k, v = qkv[0], qkv[1], qkv[2]
        scores = torch.einsum("bhqd,bhkd->bhqk", q, k) * (Dh ** -0.5)
        p = _softmax(scores, axis=-1)
        o = torch.einsum("bhqk,bhkd->bhqd", p, v)
        return (lambda x, *d: x.permute(*d))(o, 0, 2, 1, 3).reshape(B, S, D) @ wo

    def _B_ref(x, w1, b1, w2, b2):
        B, S, D = x.shape
        h = _layernorm(x, axis=-1)
        u = torch.einsum("bsd,sf->bdf", h, w1) + b1
        u = _gelu(u)
        y = torch.einsum("bdf,fs->bds", u, w2) + b2
        return (lambda x, *d: x.permute(*d))(y, 0, 2, 1)

    x = A_x
    xn = _layernorm(x, axis=-1)
    return x + _A_ref(xn, A_wqkv, A_wo) + _B_ref(xn, B_w1, B_b1, B_w2, B_b2)
```

```asm
; @launch grid=(512,1,1) block=(256,1,1) lds=81920
.amdgcn_target "amdgcn-amd-amdhsa--gfx950"
.text
.globl parallel_sum__mha_block__mixer_token_mlp__prompt_kernel
.p2align 8
.type parallel_sum__mha_block__mixer_token_mlp__prompt_kernel,@function
parallel_sum__mha_block__mixer_token_mlp__prompt_kernel:
    s_load_dwordx16 s[4:19], s[0:1], 0
    s_load_dwordx4 s[20:23], s[0:1], 64
    s_load_dwordx2 s[24:25], s[0:1], 80
    s_lshr_b32 s3, s2, 3
    s_cmp_lg_u32 s3, 31
    s_cbranch_scc1 L_nopf_6
    s_getpc_b64 s[28:29]
L_pc_7:
    v_lshlrev_b32 v2, 7, v0
    v_min_u32 v2, CODE_BYTES-(L_pc_7-parallel_sum__mha_block__mixer_token_mlp__prompt_kernel)-4, v2
    v_mov_b32 v5, s29
    v_add_co_u32 v4, vcc, s28, v2
    s_nop 1
    v_addc_co_u32 v5, vcc, 0, v5, vcc
    global_load_dword v255, v[4:5], off
L_nopf_6:
    v_lshrrev_b32 v1, 6, v0
    s_and_b32 s27, s2, 255
    v_readfirstlane_b32 s26, v1
    v_and_b32 v1, 63, v0
    s_cmp_ge_u32 s2, 256
    s_cbranch_scc1 L_apart_2
    s_setprio 3
    s_mul_i32 s57, s26, 20480
    v_lshrrev_b32 v193, 5, v1
    v_and_b32 v194, 31, v1
    v_mul_u32_u24 v195, 1280, v193
    v_lshl_add_u32 v195, v194, 3, v195
    s_lshl_b32 s52, s27, 2
    s_add_u32 s52, s52, s26
    s_mul_i32 s52, s52, 2560
    s_waitcnt lgkmcnt(0)
    s_mov_b32 s36, s4
    s_mov_b32 s37, s5
    s_mov_b32 s38, 0x280000
    s_mov_b32 s39, 0x20000
    buffer_load_dwordx2 v[104:105], v195, s[36:39], s52 offen offset:0
    buffer_load_dwordx2 v[106:107], v195, s[36:39], s52 offen offset:256
    buffer_load_dwordx2 v[108:109], v195, s[36:39], s52 offen offset:512
    buffer_load_dwordx2 v[110:111], v195, s[36:39], s52 offen offset:768
    buffer_load_dwordx2 v[112:113], v195, s[36:39], s52 offen offset:1024
    s_mov_b32 s44, s6
    s_mov_b32 s45, s7
    s_mov_b32 s46, 0x258000
    s_mov_b32 s47, 0x20000
    s_lshl_b32 s53, s27, 2
    s_add_u32 s53, s53, s26
    s_mul_i32 s53, s53, 2432
    v_lshlrev_b32 v196, 7, v1
    s_mov_b64 exec, 0x7ffff
    buffer_load_dword v198, v196, s[44:47], s53 offen
    s_mov_b64 exec, -1
    s_mov_b32 s44, s22
    s_mov_b32 s45, s23
    s_mov_b32 s46, 0x100
    s_mov_b32 s47, 0x20000
    s_or_b32 s53, s27, s26
    s_cmp_lg_u32 s53, 0
    s_cbranch_scc1 L_notag_8
    s_memrealtime s[28:29]
    v_mov_b32 v196, 0
    s_waitcnt lgkmcnt(0)
    s_or_b32 s29, s29, 0x80000000
    v_mov_b32 v204, s28
    v_mov_b32 v205, s29
    s_mov_b64 exec, 1
    buffer_store_dwordx2 v[204:205], v196, s[44:47], 0 offen offset:128 sc1
    s_mov_b64 exec, -1
L_notag_8:
    s_branch L_bpart_5
L_apart_2:
    s_cmp_ge_u32 s2, 512
    s_cbranch_scc1 L_end_1
    s_setprio 2
    s_cmp_ge_u32 s27, 240
    s_cbranch_scc1 L_spare_4
    s_lshr_b32 s52, s27, 3
    s_mul_i32 s48, s52, 205
    s_lshr_b32 s48, s48, 10
    s_mul_i32 s49, s48, 5
    s_sub_u32 s51, s52, s49
    s_and_b32 s49, s27, 7
    s_mul_i32 s49, s49, 6
    s_add_u32 s48, s48, s49
    s_and_b32 s50, s48, 15
    s_add_u32 s58, s51, s50
    s_mul_i32 s49, s58, 205
    s_lshr_b32 s49, s49, 10
    s_mul_i32 s49, s49, 5
    s_sub_u32 s58, s58, s49
    s_lshl_b32 s58, s58, 1
    s_mov_b32 s58, 0
    s_lshr_b32 s48, s48, 4
    s_cmp_eq_u32 s48, 0
    s_cselect_b32 s57, 0x3ea52b5c, 1.0
    s_mul_i32 s48, s48, 5
    s_add_u32 s51, s51, s48
    v_lshrrev_b32 v180, 4, v1
    s_lshl_b32 s48, s26, 4
    v_add_u32 v178, s48, v180
    v_mul_u32_u24 v178, 3840, v178
    v_and_b32 v179, 15, v1
    v_lshlrev_b32 v181, 2, v180
    v_xor_b32 v179, v179, v181
    v_lshl_add_u32 v156, v179, 4, v178
    v_lshrrev_b32 v178, 3, v1
    v_mul_u32_u24 v178, 1280, v178
    v_and_b32 v179, 7, v1
    v_xor_b32 v179, v179, v180
    v_xor_b32 v181, 0, v179
    v_lshl_add_u32 v160, v181, 4, v178
    v_add_u32 v157, 14336, v156
    v_xor_b32 v181, 4, v179
    v_lshl_add_u32 v161, v181, 4, v178
    v_add_u32 v161, 9216, v161
    v_add_u32 v158, 28672, v156
    v_xor_b32 v181, 0, v179
    v_lshl_add_u32 v162, v181, 4, v178
    v_add_u32 v162, 18432, v162
    v_add_u32 v159, 43008, v156
    v_xor_b32 v181, 4, v179
    v_lshl_add_u32 v163, v181, 4, v178
    v_add_u32 v163, 27648, v163
    s_lshl_b32 s59, s51, 8
    s_lshl_b32 s60, s50, 2
    s_add_u32 s60, s60, s26
    s_mul_i32 s60, s60, 40960
    s_lshl_b32 s54, s26, 12
    s_lshl_b32 s55, s26, 13
    s_add_u32 s55, s55, 49152
    s_waitcnt lgkmcnt(0)
    s_mov_b32 s32, s6
    s_mov_b32 s33, s7
    s_mov_b32 s34, 0x258000
    s_mov_b32 s35, 0x20000
    s_mov_b32 s36, s4
    s_mov_b32 s37, s5
    s_mov_b32 s38, 0x280000
    s_mov_b32 s39, 0x20000
    s_add_u32 m0, s54, 0
    s_mul_i32 s52, s58, 245760
    s_lshl_b32 s53, s58, 7
    s_add_u32 s52, s52, s59
    s_add_u32 s53, s53, s60
    s_add_u32 s58, s58, 1
    s_cmp_eq_u32 s58, 10
    s_cselect_b32 s58, 0, s58
    buffer_load_dwordx4 v156, s[32:35], s52 offen offset:0 lds
    buffer_load_dwordx4 v157, s[32:35], s52 offen offset:1024 lds
    buffer_load_dwordx4 v158, s[32:35], s52 offen offset:2048 lds
    buffer_load_dwordx4 v159, s[32:35], s52 offen offset:3072 lds
    s_add_u32 m0, s55, 0
    s_nop 0
    buffer_load_dwordx4 v160, s[36:39], s53 offen offset:0 lds
    buffer_load_dwordx4 v161, s[36:39], s53 offen offset:1024 lds
    buffer_load_dwordx4 v162, s[36:39], s53 offen offset:2048 lds
    buffer_load_dwordx4 v163, s[36:39], s53 offen offset:3072 lds
    s_add_u32 m0, s54, 16384
    s_mul_i32 s52, s58, 245760
    s_lshl_b32 s53, s58, 7
    s_add_u32 s52, s52, s59
    s_add_u32 s53, s53, s60
    s_add_u32 s58, s58, 1
    s_cmp_eq_u32 s58, 10
    s_cselect_b32 s58, 0, s58
    buffer_load_dwordx4 v156, s[32:35], s52 offen offset:0 lds
    buffer_load_dwordx4 v157, s[32:35], s52 offen offset:1024 lds
    buffer_load_dwordx4 v158, s[32:35], s52 offen offset:2048 lds
    buffer_load_dwordx4 v159, s[32:35], s52 offen offset:3072 lds
    s_add_u32 m0, s55, 4096
    s_nop 0
    buffer_load_dwordx4 v160, s[36:39], s53 offen offset:0 lds
    buffer_load_dwordx4 v161, s[36:39], s53 offen offset:1024 lds
    buffer_load_dwordx4 v162, s[36:39], s53 offen offset:2048 lds
    buffer_load_dwordx4 v163, s[36:39], s53 offen offset:3072 lds
    s_mov_b32 s40, s22
    s_mov_b32 s41, s23
    s_mov_b32 s42, 0x100
    s_mov_b32 s43, 0x20000
    s_add_u32 s44, s24, 0x1180000
    s_addc_u32 s45, s25, 0
    s_mov_b32 s46, 0x40000
    s_mov_b32 s47, 0x20000
    v_lshrrev_b32 v182, 5, v1
    v_and_b32 v178, 31, v1
    v_and_b32 v183, 0x13, v178
    v_bfe_u32 v179, v178, 2, 1
    v_lshl_add_u32 v183, v179, 3, v183
    v_bfe_u32 v179, v178, 3, 1
    v_lshl_add_u32 v183, v179, 2, v183
    v_lshlrev_b32 v176, 4, v183
    v_lshl_add_u32 v177, v182, 15, v176
    v_bfe_u32 v178, v183, 1, 3
    v_xor_b32 v178, v178, v182
    v_lshlrev_b32 v178, 4, v178
    v_lshl_add_u32 v178, v183, 7, v178
    v_add_u32 v152, s55, v178
    v_bfe_u32 v178, v1, 2, 2
    v_lshl_add_u32 v179, v182, 3, v178
    v_lshlrev_b32 v179, 8, v179
    v_xor_b32 v178, s26, v178
    v_lshl_add_u32 v179, v178, 6, v179
    v_bfe_u32 v178, v1, 4, 1
    v_lshl_add_u32 v179, v178, 5, v179
    v_and_b32 v178, 1, v1
    v_lshl_add_u32 v179, v178, 4, v179
    v_bfe_u32 v178, v1, 1, 1
    v_lshl_add_u32 v148, v178, 3, v179
    v_lshrrev_b32 v178, 4, v1
    v_xor_b32 v178, v178, v1
    v_and_b32 v178, 1, v178
    v_add_u32 v178, -1, v178
    v_and_b32 v168, 0x3f803f80, v178
    v_mov_b32 v169, v168
    v_mov_b32 v170, v168
    v_mov_b32 v171, v168
    v_mov_b32 v181, 0
    s_lshl_b32 s30, s51, 4
    s_add_u32 s30, s30, s50
    s_lshl_b32 s30, s30, 7
    s_add_u32 s30, s30, 32768
    v_xor_b32 v149, 64, v148
    v_xor_b32 v153, 32, v152
    v_xor_b32 v150, 128, v148
    v_xor_b32 v154, 64, v152
    v_xor_b32 v151, 192, v148
    v_xor_b32 v155, 96, v152
    s_waitcnt vmcnt(8) lgkmcnt(0)
    s_barrier
    ds_read_b128 v[68:71], v152 offset:0
    ds_read_b128 v[72:75], v153 offset:0
    ds_read_b128 v[76:79], v154 offset:0
    ds_read_b128 v[80:83], v155 offset:0
    ds_read_b64_tr_b16 v[100:101], v148 offset:0
    ds_read_b64_tr_b16 v[102:103], v148 offset:1024
    ds_read_b64_tr_b16 v[104:105], v149 offset:0
    ds_read_b64_tr_b16 v[106:107], v149 offset:1024
    ds_read_b64_tr_b16 v[108:109], v150 offset:0
    ds_read_b64_tr_b16 v[110:111], v150 offset:1024
    ds_read_b64_tr_b16 v[112:113], v151 offset:0
    ds_read_b64_tr_b16 v[114:115], v151 offset:1024
    s_add_u32 m0, s54, 32768
    s_mul_i32 s52, s58, 245760
    s_lshl_b32 s53, s58, 7
    s_add_u32 s52, s52, s59
    s_add_u32 s53, s53, s60
    s_add_u32 s58, s58, 1
    s_cmp_eq_u32 s58, 10
    s_cselect_b32 s58, 0, s58
    buffer_load_dwordx4 v156, s[32:35], s52 offen offset:0 lds
    buffer_load_dwordx4 v157, s[32:35], s52 offen offset:1024 lds
    ds_read_b64_tr_b16 v[116:117], v148 offset:4096
    ds_read_b64_tr_b16 v[118:119], v148 offset:5120
    ds_read_b64_tr_b16 v[120:121], v149 offset:4096
    ds_read_b64_tr_b16 v[122:123], v149 offset:5120
    ds_read_b64_tr_b16 v[124:125], v150 offset:4096
    ds_read_b64_tr_b16 v[126:127], v150 offset:5120
    ds_read_b64_tr_b16 v[128:129], v151 offset:4096
    ds_read_b64_tr_b16 v[130:131], v151 offset:5120
    buffer_load_dwordx4 v158, s[32:35], s52 offen offset:2048 lds
    buffer_load_dwordx4 v159, s[32:35], s52 offen offset:3072 lds
    s_waitcnt lgkmcnt(8)
    v_mfma_f32_32x32x16_bf16 v[4:19], v[100:103], v[68:71], 0
    ds_read_b64_tr_b16 v[132:133], v148 offset:8192
    ds_read_b64_tr_b16 v[134:135], v148 offset:9216
    ds_read_b64_tr_b16 v[136:137], v149 offset:8192
    v_mfma_f32_32x32x16_bf16 v[20:35], v[104:107], v[68:71], 0
    ds_read_b64_tr_b16 v[138:139], v149 offset:9216
    ds_read_b64_tr_b16 v[140:141], v150 offset:8192
    ds_read_b64_tr_b16 v[142:143], v150 offset:9216
    s_add_u32 m0, s55, 0
    s_nop 0
    buffer_load_dwordx4 v160, s[36:39], s53 offen offset:0 lds
    v_mfma_f32_32x32x16_bf16 v[36:51], v[108:111], v[68:71], 0
    ds_read_b64_tr_b16 v[144:145], v151 offset:8192
    ds_read_b64_tr_b16 v[146:147], v151 offset:9216
    v_mfma_f32_32x32x16_bf16 v[52:67], v[112:115], v[68:71], 0
    buffer_load_dwordx4 v161, s[36:39], s53 offen offset:1024 lds
    v_mfma_f32_16x16x32_bf16 v[164:167], v[168:171], v[100:103], 0
    s_waitcnt lgkmcnt(8)
    v_mfma_f32_32x32x16_bf16 v[4:19], v[116:119], v[72:75], v[4:19]
    ds_read_b64_tr_b16 v[100:101], v148 offset:12288
    ds_read_b64_tr_b16 v[102:103], v148 offset:13312
    ds_read_b64_tr_b16 v[104:105], v149 offset:12288
    v_mfma_f32_32x32x16_bf16 v[20:35], v[120:123], v[72:75], v[20:35]
    ds_read_b64_tr_b16 v[106:107], v149 offset:13312
    ds_read_b64_tr_b16 v[108:109], v150 offset:12288
    ds_read_b64_tr_b16 v[110:111], v150 offset:13312
    buffer_load_dwordx4 v162, s[36:39], s53 offen offset:2048 lds
    v_mfma_f32_32x32x16_bf16 v[36:51], v[124:127], v[72:75], v[36:51]
    ds_read_b64_tr_b16 v[112:113], v151 offset:12288
    ds_read_b64_tr_b16 v[114:115], v151 offset:13312
    v_mfma_f32_32x32x16_bf16 v[52:67], v[128:131], v[72:75], v[52:67]
    buffer_load_dwordx4 v163, s[36:39], s53 offen offset:3072 lds
    v_mfma_f32_16x16x32_bf16 v[164:167], v[168:171], v[116:119], v[164:167]
    s_waitcnt vmcnt(8) lgkmcnt(0)
    s_barrier
    v_mfma_f32_32x32x16_bf16 v[4:19], v[132:135], v[76:79], v[4:19]
    ds_read_b128 v[84:87], v152 offset:4096
    ds_read_b128 v[88:91], v153 offset:4096
    ds_read_b128 v[92:95], v154 offset:4096
    v_mfma_f32_32x32x16_bf16 v[20:35], v[136:139], v[76:79], v[20:35]
    ds_read_b128 v[96:99], v155 offset:4096
    ds_read_b64_tr_b16 v[116:117], v148 offset:16384
    ds_read_b64_tr_b16 v[118:119], v148 offset:17408
    s_add_u32 m0, s54, 0
    s_mul_i32 s52, s58, 245760
    s_lshl_b32 s53, s58, 7
    s_add_u32 s52, s52, s59
    s_add_u32 s53, s53, s60
    s_add_u32 s58, s58, 1
    s_cmp_eq_u32 s58, 10
    s_cselect_b32 s58, 0, s58
    buffer_load_dwordx4 v156, s[32:35], s52 offen offset:0 lds
    v_mfma_f32_32x32x16_bf16 v[36:51], v[140:143], v[76:79], v[36:51]
    ds_read_b64_tr_b16 v[120:121], v149 offset:16384
    ds_read_b64_tr_b16 v[122:123], v149 offset:17408
    ds_read_b64_tr_b16 v[124:125], v150 offset:16384
    v_mfma_f32_32x32x16_bf16 v[52:67], v[144:147], v[76:79], v[52:67]
    ds_read_b64_tr_b16 v[126:127], v150 offset:17408
    ds_read_b64_tr_b16 v[128:129], v151 offset:16384
    ds_read_b64_tr_b16 v[130:131], v151 offset:17408
    buffer_load_dwordx4 v157, s[32:35], s52 offen offset:1024 lds
    v_mfma_f32_16x16x32_bf16 v[164:167], v[168:171], v[132:135], v[164:167]
    v_mfma_f32_32x32x16_bf16 v[4:19], v[100:103], v[80:83], v[4:19]
    ds_read_b64_tr_b16 v[132:133], v148 offset:20480
    ds_read_b64_tr_b16 v[134:135], v148 offset:21504
    ds_read_b64_tr_b16 v[136:137], v149 offset:20480
    v_mfma_f32_32x32x16_bf16 v[20:35], v[104:107], v[80:83], v[20:35]
    ds_read_b64_tr_b16 v[138:139], v149 offset:21504
    ds_read_b64_tr_b16 v[140:141], v150 offset:20480
    ds_read_b64_tr_b16 v[142:143], v150 offset:21504
    buffer_load_dwordx4 v158, s[32:35], s52 offen offset:2048 lds
    v_mfma_f32_32x32x16_bf16 v[36:51], v[108:111], v[80:83], v[36:51]
    ds_read_b64_tr_b16 v[144:145], v151 offset:20480
    ds_read_b64_tr_b16 v[146:147], v151 offset:21504
    v_mfma_f32_32x32x16_bf16 v[52:67], v[112:115], v[80:83], v[52:67]
    buffer_load_dwordx4 v159, s[32:35], s52 offen offset:3072 lds
    v_mfma_f32_16x16x32_bf16 v[164:167], v[168:171], v[100:103], v[164:167]
    s_waitcnt lgkmcnt(8)
    v_mfma_f32_32x32x16_bf16 v[4:19], v[116:119], v[84:87], v[4:19]
    ds_read_b64_tr_b16 v[100:101], v148 offset:24576
    ds_read_b64_tr_b16 v[102:103], v148 offset:25600
    ds_read_b64_tr_b16 v[104:105], v149 offset:24576
    v_mfma_f32_32x32x16_bf16 v[20:35], v[120:123], v[84:87], v[20:35]
    ds_read_b64_tr_b16 v[106:107], v149 offset:25600
    ds_read_b64_tr_b16 v[108:109], v150 offset:24576
    ds_read_b64_tr_b16 v[110:111], v150 offset:25600
    s_add_u32 m0, s55, 4096
    s_nop 0
    buffer_load_dwordx4 v160, s[36:39], s53 offen offset:0 lds
    v_mfma_f32_32x32x16_bf16 v[36:51], v[124:127], v[84:87], v[36:51]
    ds_read_b64_tr_b16 v[112:113], v151 offset:24576
    ds_read_b64_tr_b16 v[114:115], v151 offset:25600
    v_mfma_f32_32x32x16_bf16 v[52:67], v[128:131], v[84:87], v[52:67]
    buffer_load_dwordx4 v161, s[36:39], s53 offen offset:1024 lds
    v_mfma_f32_16x16x32_bf16 v[164:167], v[168:171], v[116:119], v[164:167]
    s_waitcnt lgkmcnt(8)
    v_mfma_f32_32x32x16_bf16 v[4:19], v[132:135], v[88:91], v[4:19]
    ds_read_b64_tr_b16 v[116:117], v148 offset:28672
    ds_read_b64_tr_b16 v[118:119], v148 offset:29696
    ds_read_b64_tr_b16 v[120:121], v149 offset:28672
    v_mfma_f32_32x32x16_bf16 v[20:35], v[136:139], v[88:91], v[20:35]
    ds_read_b64_tr_b16 v[122:123], v149 offset:29696
    ds_read_b64_tr_b16 v[124:125], v150 offset:28672
    ds_read_b64_tr_b16 v[126:127], v150 offset:29696
    buffer_load_dwordx4 v162, s[36:39], s53 offen offset:2048 lds
    v_mfma_f32_32x32x16_bf16 v[36:51], v[140:143], v[88:91], v[36:51]
    ds_read_b64_tr_b16 v[128:129], v151 offset:28672
    ds_read_b64_tr_b16 v[130:131], v151 offset:29696
    v_mfma_f32_32x32x16_bf16 v[52:67], v[144:147], v[88:91], v[52:67]
    buffer_load_dwordx4 v163, s[36:39], s53 offen offset:3072 lds
    v_mfma_f32_16x16x32_bf16 v[164:167], v[168:171], v[132:135], v[164:167]
    s_waitcnt vmcnt(8) lgkmcnt(0)
    s_barrier
    v_mfma_f32_32x32x16_bf16 v[4:19], v[100:103], v[92:95], v[4:19]
    ds_read_b128 v[68:71], v152 offset:0
    ds_read_b128 v[72:75], v153 offset:0
    ds_read_b128 v[76:79], v154 offset:0
    v_mfma_f32_32x32x16_bf16 v[20:35], v[104:107], v[92:95], v[20:35]
    ds_read_b128 v[80:83], v155 offset:0
    ds_read_b64_tr_b16 v[132:133], v148 offset:32768
    ds_read_b64_tr_b16 v[134:135], v148 offset:33792
    s_add_u32 m0, s54, 16384
    s_mul_i32 s52, s58, 245760
    s_lshl_b32 s53, s58, 7
    s_add_u32 s52, s52, s59
    s_add_u32 s53, s53, s60
    s_add_u32 s58, s58, 1
    s_cmp_eq_u32 s58, 10
    s_cselect_b32 s58, 0, s58
    buffer_load_dwordx4 v156, s[32:35], s52 offen offset:0 lds
    v_mfma_f32_32x32x16_bf16 v[36:51], v[108:111], v[92:95], v[36:51]
    ds_read_b64_tr_b16 v[136:137], v149 offset:32768
    ds_read_b64_tr_b16 v[138:139], v149 offset:33792
    ds_read_b64_tr_b16 v[140:141], v150 offset:32768
    v_mfma_f32_32x32x16_bf16 v[52:67], v[112:115], v[92:95], v[52:67]
    ds_read_b64_tr_b16 v[142:143], v150 offset:33792
    ds_read_b64_tr_b16 v[144:145], v151 offset:32768
    ds_read_b64_tr_b16 v[146:147], v151 offset:33792
    buffer_load_dwordx4 v157, s[32:35], s52 offen offset:1024 lds
    v_mfma_f32_16x16x32_bf16 v[164:167], v[168:171], v[100:103], v[164:167]
    v_mfma_f32_32x32x16_bf16 v[4:19], v[116:119], v[96:99], v[4:19]
    ds_read_b64_tr_b16 v[100:101], v148 offset:36864
    ds_read_b64_tr_b16 v[102:103], v148 offset:37888
    ds_read_b64_tr_b16 v[104:105], v149 offset:36864
    v_mfma_f32_32x32x16_bf16 v[20:35], v[120:123], v[96:99], v[20:35]
    ds_read_b64_tr_b16 v[106:107], v149 offset:37888
    ds_read_b64_tr_b16 v[108:109], v150 offset:36864
    ds_read_b64_tr_b16 v[110:111], v150 offset:37888
    buffer_load_dwordx4 v158, s[32:35], s52 offen offset:2048 lds
    v_mfma_f32_32x32x16_bf16 v[36:51], v[124:127], v[96:99], v[36:51]
    ds_read_b64_tr_b16 v[112:113], v151 offset:36864
    ds_read_b64_tr_b16 v[114:115], v151 offset:37888
    v_mfma_f32_32x32x16_bf16 v[52:67], v[128:131], v[96:99], v[52:67]
    buffer_load_dwordx4 v159, s[32:35], s52 offen offset:3072 lds
    v_mfma_f32_16x16x32_bf16 v[164:167], v[168:171], v[116:119], v[164:167]
    s_waitcnt lgkmcnt(8)
    v_mfma_f32_32x32x16_bf16 v[4:19], v[132:135], v[68:71], v[4:19]
    ds_read_b64_tr_b16 v[116:117], v148 offset:40960
    ds_read_b64_tr_b16 v[118:119], v148 offset:41984
    ds_read_b64_tr_b16 v[120:121], v149 offset:40960
    v_mfma_f32_32x32x16_bf16 v[20:35], v[136:139], v[68:71], v[20:35]
    ds_read_b64_tr_b16 v[122:123], v149 offset:41984
    ds_read_b64_tr_b16 v[124:125], v150 offset:40960
    ds_read_b64_tr_b16 v[126:127], v150 offset:41984
    s_add_u32 m0, s55, 0
    s_nop 0
    buffer_load_dwordx4 v160, s[36:39], s53 offen offset:0 lds
    v_mfma_f32_32x32x16_bf16 v[36:51], v[140:143], v[68:71], v[36:51]
    ds_read_b64_tr_b16 v[128:129], v151 offset:40960
    ds_read_b64_tr_b16 v[130:131], v151 offset:41984
    v_mfma_f32_32x32x16_bf16 v[52:67], v[144:147], v[68:71], v[52:67]
    buffer_load_dwordx4 v161, s[36:39], s53 offen offset:1024 lds
    v_mfma_f32_16x16x32_bf16 v[164:167], v[168:171], v[132:135], v[164:167]
    s_waitcnt lgkmcnt(8)
    v_mfma_f32_32x32x16_bf16 v[4:19], v[100:103], v[72:75], v[4:19]
    ds_read_b64_tr_b16 v[132:133], v148 offset:45056
    ds_read_b64_tr_b16 v[134:135], v148 offset:46080
    ds_read_b64_tr_b16 v[136:137], v149 offset:45056
    v_mfma_f32_32x32x16_bf16 v[20:35], v[104:107], v[72:75], v[20:35]
    ds_read_b64_tr_b16 v[138:139], v149 offset:46080
    ds_read_b64_tr_b16 v[140:141], v150 offset:45056
    ds_read_b64_tr_b16 v[142:143], v150 offset:46080
    buffer_load_dwordx4 v162, s[36:39], s53 offen offset:2048 lds
    v_mfma_f32_32x32x16_bf16 v[36:51], v[108:111], v[72:75], v[36:51]
    ds_read_b64_tr_b16 v[144:145], v151 offset:45056
    ds_read_b64_tr_b16 v[146:147], v151 offset:46080
    v_mfma_f32_32x32x16_bf16 v[52:67], v[112:115], v[72:75], v[52:67]
    buffer_load_dwordx4 v163, s[36:39], s53 offen offset:3072 lds
    v_mfma_f32_16x16x32_bf16 v[164:167], v[168:171], v[100:103], v[164:167]
    s_waitcnt vmcnt(8) lgkmcnt(0)
    s_barrier
    v_mfma_f32_32x32x16_bf16 v[4:19], v[116:119], v[76:79], v[4:19]
    ds_read_b128 v[84:87], v152 offset:4096
    ds_read_b128 v[88:91], v153 offset:4096
    ds_read_b128 v[92:95], v154 offset:4096
    v_mfma_f32_32x32x16_bf16 v[20:35], v[120:123], v[76:79], v[20:35]
    ds_read_b128 v[96:99], v155 offset:4096
    ds_read_b64_tr_b16 v[100:101], v148 offset:0
    ds_read_b64_tr_b16 v[102:103], v148 offset:1024
    s_add_u32 m0, s54, 32768
    s_mul_i32 s52, s58, 245760
    s_lshl_b32 s53, s58, 7
    s_add_u32 s52, s52, s59
    s_add_u32 s53, s53, s60
    s_add_u32 s58, s58, 1
    s_cmp_eq_u32 s58, 10
    s_cselect_b32 s58, 0, s58
    buffer_load_dwordx4 v156, s[32:35], s52 offen offset:0 lds
    v_mfma_f32_32x32x16_bf16 v[36:51], v[124:127], v[76:79], v[36:51]
    ds_read_b64_tr_b16 v[104:105], v149 offset:0
    ds_read_b64_tr_b16 v[106:107], v149 offset:1024
    ds_read_b64_tr_b16 v[108:109], v150 offset:0
    v_mfma_f32_32x32x16_bf16 v[52:67], v[128:131], v[76:79], v[52:67]
    ds_read_b64_tr_b16 v[110:111], v150 offset:1024
    ds_read_b64_tr_b16 v[112:113], v151 offset:0
    ds_read_b64_tr_b16 v[114:115], v151 offset:1024
    buffer_load_dwordx4 v157, s[32:35], s52 offen offset:1024 lds
    v_mfma_f32_16x16x32_bf16 v[164:167], v[168:171], v[116:119], v[164:167]
    buffer_load_dwordx2 v[184:185], v181, s[40:43], 0 offen offset:128 sc1
    v_mfma_f32_32x32x16_bf16 v[4:19], v[132:135], v[80:83], v[4:19]
    ds_read_b64_tr_b16 v[116:117], v148 offset:4096
    ds_read_b64_tr_b16 v[118:119], v148 offset:5120
    ds_read_b64_tr_b16 v[120:121], v149 offset:4096
    v_mfma_f32_32x32x16_bf16 v[20:35], v[136:139], v[80:83], v[20:35]
    ds_read_b64_tr_b16 v[122:123], v149 offset:5120
    ds_read_b64_tr_b16 v[124:125], v150 offset:4096
    ds_read_b64_tr_b16 v[126:127], v150 offset:5120
    buffer_load_dwordx4 v158, s[32:35], s52 offen offset:2048 lds
    v_mfma_f32_32x32x16_bf16 v[36:51], v[140:143], v[80:83], v[36:51]
    ds_read_b64_tr_b16 v[128:129], v151 offset:4096
    ds_read_b64_tr_b16 v[130:131], v151 offset:5120
    v_mfma_f32_32x32x16_bf16 v[52:67], v[144:147], v[80:83], v[52:67]
    buffer_load_dwordx4 v159, s[32:35], s52 offen offset:3072 lds
    v_mfma_f32_16x16x32_bf16 v[164:167], v[168:171], v[132:135], v[164:167]
    s_waitcnt lgkmcnt(8)
    v_mfma_f32_32x32x16_bf16 v[4:19], v[100:103], v[84:87], v[4:19]
    ds_read_b64_tr_b16 v[132:133], v148 offset:8192
    ds_read_b64_tr_b16 v[134:135], v148 offset:9216
    ds_read_b64_tr_b16 v[136:137], v149 offset:8192
    v_mfma_f32_32x32x16_bf16 v[20:35], v[104:107], v[84:87], v[20:35]
    ds_read_b64_tr_b16 v[138:139], v149 offset:9216
    ds_read_b64_tr_b16 v[140:141], v150 offset:8192
    ds_read_b64_tr_b16 v[142:143], v150 offset:9216
    s_add_u32 m0, s55, 4096
    s_nop 0
    buffer_load_dwordx4 v160, s[36:39], s53 offen offset:0 lds
    v_mfma_f32_32x32x16_bf16 v[36:51], v[108:111], v[84:87], v[36:51]
    ds_read_b64_tr_b16 v[144:145], v151 offset:8192
    ds_read_b64_tr_b16 v[146:147], v151 offset:9216
    v_mfma_f32_32x32x16_bf16 v[52:67], v[112:115], v[84:87], v[52:67]
    buffer_load_dwordx4 v161, s[36:39], s53 offen offset:1024 lds
    v_mfma_f32_16x16x32_bf16 v[164:167], v[168:171], v[100:103], v[164:167]
    s_waitcnt lgkmcnt(8)
    v_mfma_f32_32x32x16_bf16 v[4:19], v[116:119], v[88:91], v[4:19]
    ds_read_b64_tr_b16 v[100:101], v148 offset:12288
    ds_read_b64_tr_b16 v[102:103], v148 offset:13312
    ds_read_b64_tr_b16 v[104:105], v149 offset:12288
    v_mfma_f32_32x32x16_bf16 v[20:35], v[120:123], v[88:91], v[20:35]
    ds_read_b64_tr_b16 v[106:107], v149 offset:13312
    ds_read_b64_tr_b16 v[108:109], v150 offset:12288
    ds_read_b64_tr_b16 v[110:111], v150 offset:13312
    buffer_load_dwordx4 v162, s[36:39], s53 offen offset:2048 lds
    v_mfma_f32_32x32x16_bf16 v[36:51], v[124:127], v[88:91], v[36:51]
    ds_read_b64_tr_b16 v[112:113], v151 offset:12288
    ds_read_b64_tr_b16 v[114:115], v151 offset:13312
    v_mfma_f32_32x32x16_bf16 v[52:67], v[128:131], v[88:91], v[52:67]
    buffer_load_dwordx4 v163, s[36:39], s53 offen offset:3072 lds
    v_mfma_f32_16x16x32_bf16 v[164:167], v[168:171], v[116:119], v[164:167]
    s_waitcnt vmcnt(9) lgkmcnt(0)
    s_barrier
    v_mfma_f32_32x32x16_bf16 v[4:19], v[132:135], v[92:95], v[4:19]
    ds_read_b128 v[68:71], v152 offset:0
    ds_read_b128 v[72:75], v153 offset:0
    ds_read_b128 v[76:79], v154 offset:0
    v_mfma_f32_32x32x16_bf16 v[20:35], v[136:139], v[92:95], v[20:35]
    ds_read_b128 v[80:83], v155 offset:0
    ds_read_b64_tr_b16 v[116:117], v148 offset:16384
    ds_read_b64_tr_b16 v[118:119], v148 offset:17408
    s_add_u32 m0, s54, 0
    s_mul_i32 s52, s58, 245760
    s_lshl_b32 s53, s58, 7
    s_add_u32 s52, s52, s59
    s_add_u32 s53, s53, s60
    s_add_u32 s58, s58, 1
    s_cmp_eq_u32 s58, 10
    s_cselect_b32 s58, 0, s58
    buffer_load_dwordx4 v156, s[32:35], s52 offen offset:0 lds
    v_mfma_f32_32x32x16_bf16 v[36:51], v[140:143], v[92:95], v[36:51]
    ds_read_b64_tr_b16 v[120:121], v149 offset:16384
    ds_read_b64_tr_b16 v[122:123], v149 offset:17408
    ds_read_b64_tr_b16 v[124:125], v150 offset:16384
    v_mfma_f32_32x32x16_bf16 v[52:67], v[144:147], v[92:95], v[52:67]
    ds_read_b64_tr_b16 v[126:127], v150 offset:17408
    ds_read_b64_tr_b16 v[128:129], v151 offset:16384
    ds_read_b64_tr_b16 v[130:131], v151 offset:17408
    buffer_load_dwordx4 v157, s[32:35], s52 offen offset:1024 lds
    v_mfma_f32_16x16x32_bf16 v[164:167], v[168:171], v[132:135], v[164:167]
    v_mfma_f32_32x32x16_bf16 v[4:19], v[100:103], v[96:99], v[4:19]
    ds_read_b64_tr_b16 v[132:133], v148 offset:20480
    ds_read_b64_tr_b16 v[134:135], v148 offset:21504
    ds_read_b64_tr_b16 v[136:137], v149 offset:20480
    v_mfma_f32_32x32x16_bf16 v[20:35], v[104:107], v[96:99], v[20:35]
    ds_read_b64_tr_b16 v[138:139], v149 offset:21504
    ds_read_b64_tr_b16 v[140:141], v150 offset:20480
    ds_read_b64_tr_b16 v[142:143], v150 offset:21504
    buffer_load_dwordx4 v158, s[32:35], s52 offen offset:2048 lds
    v_mfma_f32_32x32x16_bf16 v[36:51], v[108:111], v[96:99], v[36:51]
    ds_read_b64_tr_b16 v[144:145], v151 offset:20480
    ds_read_b64_tr_b16 v[146:147], v151 offset:21504
    v_mfma_f32_32x32x16_bf16 v[52:67], v[112:115], v[96:99], v[52:67]
    buffer_load_dwordx4 v159, s[32:35], s52 offen offset:3072 lds
    v_mfma_f32_16x16x32_bf16 v[164:167], v[168:171], v[100:103], v[164:167]
    s_waitcnt lgkmcnt(8)
    v_mfma_f32_32x32x16_bf16 v[4:19], v[116:119], v[68:71], v[4:19]
    ds_read_b64_tr_b16 v[100:101], v148 offset:24576
    ds_read_b64_tr_b16 v[102:103], v148 offset:25600
    ds_read_b64_tr_b16 v[104:105], v149 offset:24576
    v_mfma_f32_32x32x16_bf16 v[20:35], v[120:123], v[68:71], v[20:35]
    ds_read_b64_tr_b16 v[106:107], v149 offset:25600
    ds_read_b64_tr_b16 v[108:109], v150 offset:24576
    ds_read_b64_tr_b16 v[110:111], v150 offset:25600
    s_add_u32 m0, s55, 0
    s_nop 0
    buffer_load_dwordx4 v160, s[36:39], s53 offen offset:0 lds
    v_mfma_f32_32x32x16_bf16 v[36:51], v[124:127], v[68:71], v[36:51]
    ds_read_b64_tr_b16 v[112:113], v151 offset:24576
    ds_read_b64_tr_b16 v[114:115], v151 offset:25600
    v_mfma_f32_32x32x16_bf16 v[52:67], v[128:131], v[68:71], v[52:67]
    buffer_load_dwordx4 v161, s[36:39], s53 offen offset:1024 lds
    v_mfma_f32_16x16x32_bf16 v[164:167], v[168:171], v[116:119], v[164:167]
    s_waitcnt lgkmcnt(8)
    v_mfma_f32_32x32x16_bf16 v[4:19], v[132:135], v[72:75], v[4:19]
    ds_read_b64_tr_b16 v[116:117], v148 offset:28672
    ds_read_b64_tr_b16 v[118:119], v148 offset:29696
    ds_read_b64_tr_b16 v[120:121], v149 offset:28672
    v_mfma_f32_32x32x16_bf16 v[20:35], v[136:139], v[72:75], v[20:35]
    ds_read_b64_tr_b16 v[122:123], v149 offset:29696
    ds_read_b64_tr_b16 v[124:125], v150 offset:28672
    ds_read_b64_tr_b16 v[126:127], v150 offset:29696
    buffer_load_dwordx4 v162, s[36:39], s53 offen offset:2048 lds
    v_mfma_f32_32x32x16_bf16 v[36:51], v[140:143], v[72:75], v[36:51]
    ds_read_b64_tr_b16 v[128:129], v151 offset:28672
    ds_read_b64_tr_b16 v[130:131], v151 offset:29696
    v_mfma_f32_32x32x16_bf16 v[52:67], v[144:147], v[72:75], v[52:67]
    buffer_load_dwordx4 v163, s[36:39], s53 offen offset:3072 lds
    v_mfma_f32_16x16x32_bf16 v[164:167], v[168:171], v[132:135], v[164:167]
    s_waitcnt vmcnt(8) lgkmcnt(0)
    s_barrier
    v_mfma_f32_32x32x16_bf16 v[4:19], v[100:103], v[76:79], v[4:19]
    ds_read_b128 v[84:87], v152 offset:4096
    ds_read_b128 v[88:91], v153 offset:4096
    ds_read_b128 v[92:95], v154 offset:4096
    v_mfma_f32_32x32x16_bf16 v[20:35], v[104:107], v[76:79], v[20:35]
    ds_read_b128 v[96:99], v155 offset:4096
    ds_read_b64_tr_b16 v[132:133], v148 offset:32768
    ds_read_b64_tr_b16 v[134:135], v148 offset:33792
    s_add_u32 m0, s54, 16384
    s_mul_i32 s52, s58, 245760
    s_lshl_b32 s53, s58, 7
    s_add_u32 s52, s52, s59
    s_add_u32 s53, s53, s60
    s_add_u32 s58, s58, 1
    s_cmp_eq_u32 s58, 10
    s_cselect_b32 s58, 0, s58
    buffer_load_dwordx4 v156, s[32:35], s52 offen offset:0 lds
    v_mfma_f32_32x32x16_bf16 v[36:51], v[108:111], v[76:79], v[36:51]
    ds_read_b64_tr_b16 v[136:137], v149 offset:32768
    ds_read_b64_tr_b16 v[138:139], v149 offset:33792
    ds_read_b64_tr_b16 v[140:141], v150 offset:32768
    v_mfma_f32_32x32x16_bf16 v[52:67], v[112:115], v[76:79], v[52:67]
    ds_read_b64_tr_b16 v[142:143], v150 offset:33792
    ds_read_b64_tr_b16 v[144:145], v151 offset:32768
    ds_read_b64_tr_b16 v[146:147], v151 offset:33792
    buffer_load_dwordx4 v157, s[32:35], s52 offen offset:1024 lds
    v_mfma_f32_16x16x32_bf16 v[164:167], v[168:171], v[100:103], v[164:167]
    v_mfma_f32_32x32x16_bf16 v[4:19], v[116:119], v[80:83], v[4:19]
    ds_read_b64_tr_b16 v[100:101], v148 offset:36864
    ds_read_b64_tr_b16 v[102:103], v148 offset:37888
    ds_read_b64_tr_b16 v[104:105], v149 offset:36864
    v_mfma_f32_32x32x16_bf16 v[20:35], v[120:123], v[80:83], v[20:35]
    ds_read_b64_tr_b16 v[106:107], v149 offset:37888
    ds_read_b64_tr_b16 v[108:109], v150 offset:36864
    ds_read_b64_tr_b16 v[110:111], v150 offset:37888
    buffer_load_dwordx4 v158, s[32:35], s52 offen offset:2048 lds
    v_mfma_f32_32x32x16_bf16 v[36:51], v[124:127], v[80:83], v[36:51]
    ds_read_b64_tr_b16 v[112:113], v151 offset:36864
    ds_read_b64_tr_b16 v[114:115], v151 offset:37888
    v_mfma_f32_32x32x16_bf16 v[52:67], v[128:131], v[80:83], v[52:67]
    buffer_load_dwordx4 v159, s[32:35], s52 offen offset:3072 lds
    v_mfma_f32_16x16x32_bf16 v[164:167], v[168:171], v[116:119], v[164:167]
    s_waitcnt lgkmcnt(8)
    v_mfma_f32_32x32x16_bf16 v[4:19], v[132:135], v[84:87], v[4:19]
    ds_read_b64_tr_b16 v[116:117], v148 offset:40960
    ds_read_b64_tr_b16 v[118:119], v148 offset:41984
    ds_read_b64_tr_b16 v[120:121], v149 offset:40960
    v_mfma_f32_32x32x16_bf16 v[20:35], v[136:139], v[84:87], v[20:35]
    ds_read_b64_tr_b16 v[122:123], v149 offset:41984
    ds_read_b64_tr_b16 v[124:125], v150 offset:40960
    ds_read_b64_tr_b16 v[126:127], v150 offset:41984
    s_add_u32 m0, s55, 4096
    s_nop 0
    buffer_load_dwordx4 v160, s[36:39], s53 offen offset:0 lds
    v_mfma_f32_32x32x16_bf16 v[36:51], v[140:143], v[84:87], v[36:51]
    ds_read_b64_tr_b16 v[128:129], v151 offset:40960
    ds_read_b64_tr_b16 v[130:131], v151 offset:41984
    v_mfma_f32_32x32x16_bf16 v[52:67], v[144:147], v[84:87], v[52:67]
    buffer_load_dwordx4 v161, s[36:39], s53 offen offset:1024 lds
    v_mfma_f32_16x16x32_bf16 v[164:167], v[168:171], v[132:135], v[164:167]
    s_waitcnt lgkmcnt(8)
    v_mfma_f32_32x32x16_bf16 v[4:19], v[100:103], v[88:91], v[4:19]
    ds_read_b64_tr_b16 v[132:133], v148 offset:45056
    ds_read_b64_tr_b16 v[134:135], v148 offset:46080
    ds_read_b64_tr_b16 v[136:137], v149 offset:45056
    v_mfma_f32_32x32x16_bf16 v[20:35], v[104:107], v[88:91], v[20:35]
    ds_read_b64_tr_b16 v[138:139], v149 offset:46080
    ds_read_b64_tr_b16 v[140:141], v150 offset:45056
    ds_read_b64_tr_b16 v[142:143], v150 offset:46080
    buffer_load_dwordx4 v162, s[36:39], s53 offen offset:2048 lds
    v_mfma_f32_32x32x16_bf16 v[36:51], v[108:111], v[88:91], v[36:51]
    ds_read_b64_tr_b16 v[144:145], v151 offset:45056
    ds_read_b64_tr_b16 v[146:147], v151 offset:46080
    v_mfma_f32_32x32x16_bf16 v[52:67], v[112:115], v[88:91], v[52:67]
    buffer_load_dwordx4 v163, s[36:39], s53 offen offset:3072 lds
    v_mfma_f32_16x16x32_bf16 v[164:167], v[168:171], v[100:103], v[164:167]
    s_waitcnt vmcnt(8) lgkmcnt(0)
    s_barrier
    v_mfma_f32_32x32x16_bf16 v[4:19], v[116:119], v[92:95], v[4:19]
    ds_read_b128 v[68:71], v152 offset:0
    ds_read_b128 v[72:75], v153 offset:0
    ds_read_b128 v[76:79], v154 offset:0
    v_mfma_f32_32x32x16_bf16 v[20:35], v[120:123], v[92:95], v[20:35]
    ds_read_b128 v[80:83], v155 offset:0
    ds_read_b64_tr_b16 v[100:101], v148 offset:0
    ds_read_b64_tr_b16 v[102:103], v148 offset:1024
    s_add_u32 m0, s54, 32768
    s_mul_i32 s52, s58, 245760
    s_lshl_b32 s53, s58, 7
    s_add_u32 s52, s52, s59
    s_add_u32 s53, s53, s60
    s_add_u32 s58, s58, 1
    s_cmp_eq_u32 s58, 10
    s_cselect_b32 s58, 0, s58
    buffer_load_dwordx4 v156, s[32:35], s52 offen offset:0 lds
    v_mfma_f32_32x32x16_bf16 v[36:51], v[124:127], v[92:95], v[36:51]
    ds_read_b64_tr_b16 v[104:105], v149 offset:0
    ds_read_b64_tr_b16 v[106:107], v149 offset:1024
    ds_read_b64_tr_b16 v[108:109], v150 offset:0
    v_mfma_f32_32x32x16_bf16 v[52:67], v[128:131], v[92:95], v[52:67]
    ds_read_b64_tr_b16 v[110:111], v150 offset:1024
    ds_read_b64_tr_b16 v[112:113], v151 offset:0
    ds_read_b64_tr_b16 v[114:115], v151 offset:1024
    buffer_load_dwordx4 v157, s[32:35], s52 offen offset:1024 lds
    v_mfma_f32_16x16x32_bf16 v[164:167], v[168:171], v[116:119], v[164:167]
    v_mfma_f32_32x32x16_bf16 v[4:19], v[132:135], v[96:99], v[4:19]
    ds_read_b64_tr_b16 v[116:117], v148 offset:4096
    ds_read_b64_tr_b16 v[118:119], v148 offset:5120
    ds_read_b64_tr_b16 v[120:121], v149 offset:4096
    v_mfma_f32_32x32x16_bf16 v[20:35], v[136:139], v[96:99], v[20:35]
    ds_read_b64_tr_b16 v[122:123], v149 offset:5120
    ds_read_b64_tr_b16 v[124:125], v150 offset:4096
    ds_read_b64_tr_b16 v[126:127], v150 offset:5120
    buffer_load_dwordx4 v158, s[32:35], s52 offen offset:2048 lds
    v_mfma_f32_32x32x16_bf16 v[36:51], v[140:143], v[96:99], v[36:51]
    ds_read_b64_tr_b16 v[128:129], v151 offset:4096
    ds_read_b64_tr_b16 v[130:131], v151 offset:5120
    v_mfma_f32_32x32x16_bf16 v[52:67], v[144:147], v[96:99], v[52:67]
    buffer_load_dwordx4 v159, s[32:35], s52 offen offset:3072 lds
    v_mfma_f32_16x16x32_bf16 v[164:167], v[168:171], v[132:135], v[164:167]
    s_waitcnt lgkmcnt(8)
    v_mfma_f32_32x32x16_bf16 v[4:19], v[100:103], v[68:71], v[4:19]
    ds_read_b64_tr_b16 v[132:133], v148 offset:8192
    ds_read_b64_tr_b16 v[134:135], v148 offset:9216
    ds_read_b64_tr_b16 v[136:137], v149 offset:8192
    v_mfma_f32_32x32x16_bf16 v[20:35], v[104:107], v[68:71], v[20:35]
    ds_read_b64_tr_b16 v[138:139], v149 offset:9216
    ds_read_b64_tr_b16 v[140:141], v150 offset:8192
    ds_read_b64_tr_b16 v[142:143], v150 offset:9216
    s_add_u32 m0, s55, 0
    s_nop 0
    buffer_load_dwordx4 v160, s[36:39], s53 offen offset:0 lds
    v_mfma_f32_32x32x16_bf16 v[36:51], v[108:111], v[68:71], v[36:51]
    ds_read_b64_tr_b16 v[144:145], v151 offset:8192
    ds_read_b64_tr_b16 v[146:147], v151 offset:9216
    v_mfma_f32_32x32x16_bf16 v[52:67], v[112:115], v[68:71], v[52:67]
    buffer_load_dwordx4 v161, s[36:39], s53 offen offset:1024 lds
    v_mfma_f32_16x16x32_bf16 v[164:167], v[168:171], v[100:103], v[164:167]
    s_waitcnt lgkmcnt(8)
    v_mfma_f32_32x32x16_bf16 v[4:19], v[116:119], v[72:75], v[4:19]
    ds_read_b64_tr_b16 v[100:101], v148 offset:12288
    ds_read_b64_tr_b16 v[102:103], v148 offset:13312
    ds_read_b64_tr_b16 v[104:105], v149 offset:12288
    v_mfma_f32_32x32x16_bf16 v[20:35], v[120:123], v[72:75], v[20:35]
    ds_read_b64_tr_b16 v[106:107], v149 offset:13312
    ds_read_b64_tr_b16 v[108:109], v150 offset:12288
    ds_read_b64_tr_b16 v[110:111], v150 offset:13312
    buffer_load_dwordx4 v162, s[36:39], s53 offen offset:2048 lds
    v_mfma_f32_32x32x16_bf16 v[36:51], v[124:127], v[72:75], v[36:51]
    ds_read_b64_tr_b16 v[112:113], v151 offset:12288
    ds_read_b64_tr_b16 v[114:115], v151 offset:13312
    v_mfma_f32_32x32x16_bf16 v[52:67], v[128:131], v[72:75], v[52:67]
    buffer_load_dwordx4 v163, s[36:39], s53 offen offset:3072 lds
    v_mfma_f32_16x16x32_bf16 v[164:167], v[168:171], v[116:119], v[164:167]
    s_waitcnt vmcnt(8) lgkmcnt(0)
    s_barrier
    v_mfma_f32_32x32x16_bf16 v[4:19], v[132:135], v[76:79], v[4:19]
    ds_read_b128 v[84:87], v152 offset:4096
    ds_read_b128 v[88:91], v153 offset:4096
    ds_read_b128 v[92:95], v154 offset:4096
    v_mfma_f32_32x32x16_bf16 v[20:35], v[136:139], v[76:79], v[20:35]
    ds_read_b128 v[96:99], v155 offset:4096
    ds_read_b64_tr_b16 v[116:117], v148 offset:16384
    ds_read_b64_tr_b16 v[118:119], v148 offset:17408
    s_add_u32 m0, s54, 0
    s_mul_i32 s52, s58, 245760
    s_lshl_b32 s53, s58, 7
    s_add_u32 s52, s52, s59
    s_add_u32 s53, s53, s60
    s_add_u32 s58, s58, 1
    s_cmp_eq_u32 s58, 10
    s_cselect_b32 s58, 0, s58
    buffer_load_dwordx4 v156, s[32:35], s52 offen offset:0 lds
    v_mfma_f32_32x32x16_bf16 v[36:51], v[140:143], v[76:79], v[36:51]
    ds_read_b64_tr_b16 v[120:121], v149 offset:16384
    ds_read_b64_tr_b16 v[122:123], v149 offset:17408
    ds_read_b64_tr_b16 v[124:125], v150 offset:16384
    v_mfma_f32_32x32x16_bf16 v[52:67], v[144:147], v[76:79], v[52:67]
    ds_read_b64_tr_b16 v[126:127], v150 offset:17408
    ds_read_b64_tr_b16 v[128:129], v151 offset:16384
    ds_read_b64_tr_b16 v[130:131], v151 offset:17408
    buffer_load_dwordx4 v157, s[32:35], s52 offen offset:1024 lds
    v_mfma_f32_16x16x32_bf16 v[164:167], v[168:171], v[132:135], v[164:167]
    v_mfma_f32_32x32x16_bf16 v[4:19], v[100:103], v[80:83], v[4:19]
    ds_read_b64_tr_b16 v[132:133], v148 offset:20480
    ds_read_b64_tr_b16 v[134:135], v148 offset:21504
    ds_read_b64_tr_b16 v[136:137], v149 offset:20480
    v_mfma_f32_32x32x16_bf16 v[20:35], v[104:107], v[80:83], v[20:35]
    ds_read_b64_tr_b16 v[138:139], v149 offset:21504
    ds_read_b64_tr_b16 v[140:141], v150 offset:20480
    ds_read_b64_tr_b16 v[142:143], v150 offset:21504
    buffer_load_dwordx4 v158, s[32:35], s52 offen offset:2048 lds
    v_mfma_f32_32x32x16_bf16 v[36:51], v[108:111], v[80:83], v[36:51]
    ds_read_b64_tr_b16 v[144:145], v151 offset:20480
    ds_read_b64_tr_b16 v[146:147], v151 offset:21504
    v_mfma_f32_32x32x16_bf16 v[52:67], v[112:115], v[80:83], v[52:67]
    buffer_load_dwordx4 v159, s[32:35], s52 offen offset:3072 lds
    v_mfma_f32_16x16x32_bf16 v[164:167], v[168:171], v[100:103], v[164:167]
    s_waitcnt lgkmcnt(8)
    v_mfma_f32_32x32x16_bf16 v[4:19], v[116:119], v[84:87], v[4:19]
    ds_read_b64_tr_b16 v[100:101], v148 offset:24576
    ds_read_b64_tr_b16 v[102:103], v148 offset:25600
    ds_read_b64_tr_b16 v[104:105], v149 offset:24576
    v_mfma_f32_32x32x16_bf16 v[20:35], v[120:123], v[84:87], v[20:35]
    ds_read_b64_tr_b16 v[106:107], v149 offset:25600
    ds_read_b64_tr_b16 v[108:109], v150 offset:24576
    ds_read_b64_tr_b16 v[110:111], v150 offset:25600
    s_add_u32 m0, s55, 4096
    s_nop 0
    buffer_load_dwordx4 v160, s[36:39], s53 offen offset:0 lds
    v_mfma_f32_32x32x16_bf16 v[36:51], v[124:127], v[84:87], v[36:51]
    ds_read_b64_tr_b16 v[112:113], v151 offset:24576
    ds_read_b64_tr_b16 v[114:115], v151 offset:25600
    v_mfma_f32_32x32x16_bf16 v[52:67], v[128:131], v[84:87], v[52:67]
    buffer_load_dwordx4 v161, s[36:39], s53 offen offset:1024 lds
    v_mfma_f32_16x16x32_bf16 v[164:167], v[168:171], v[116:119], v[164:167]
    s_waitcnt lgkmcnt(8)
    v_mfma_f32_32x32x16_bf16 v[4:19], v[132:135], v[88:91], v[4:19]
    ds_read_b64_tr_b16 v[116:117], v148 offset:28672
    ds_read_b64_tr_b16 v[118:119], v148 offset:29696
    ds_read_b64_tr_b16 v[120:121], v149 offset:28672
    v_mfma_f32_32x32x16_bf16 v[20:35], v[136:139], v[88:91], v[20:35]
    ds_read_b64_tr_b16 v[122:123], v149 offset:29696
    ds_read_b64_tr_b16 v[124:125], v150 offset:28672
    ds_read_b64_tr_b16 v[126:127], v150 offset:29696
    buffer_load_dwordx4 v162, s[36:39], s53 offen offset:2048 lds
    v_mfma_f32_32x32x16_bf16 v[36:51], v[140:143], v[88:91], v[36:51]
    ds_read_b64_tr_b16 v[128:129], v151 offset:28672
    ds_read_b64_tr_b16 v[130:131], v151 offset:29696
    v_mfma_f32_32x32x16_bf16 v[52:67], v[144:147], v[88:91], v[52:67]
    buffer_load_dwordx4 v163, s[36:39], s53 offen offset:3072 lds
    v_mfma_f32_16x16x32_bf16 v[164:167], v[168:171], v[132:135], v[164:167]
    s_waitcnt vmcnt(8) lgkmcnt(0)
    s_barrier
    v_mfma_f32_32x32x16_bf16 v[4:19], v[100:103], v[92:95], v[4:19]
    ds_read_b128 v[68:71], v152 offset:0
    ds_read_b128 v[72:75], v153 offset:0
    ds_read_b128 v[76:79], v154 offset:0
    v_mfma_f32_32x32x16_bf16 v[20:35], v[104:107], v[92:95], v[20:35]
    ds_read_b128 v[80:83], v155 offset:0
    ds_read_b64_tr_b16 v[132:133], v148 offset:32768
    ds_read_b64_tr_b16 v[134:135], v148 offset:33792
    v_mfma_f32_32x32x16_bf16 v[36:51], v[108:111], v[92:95], v[36:51]
    ds_read_b64_tr_b16 v[136:137], v149 offset:32768
    ds_read_b64_tr_b16 v[138:139], v149 offset:33792
    ds_read_b64_tr_b16 v[140:141], v150 offset:32768
    v_mfma_f32_32x32x16_bf16 v[52:67], v[112:115], v[92:95], v[52:67]
    ds_read_b64_tr_b16 v[142:143], v150 offset:33792
    ds_read_b64_tr_b16 v[144:145], v151 offset:32768
    ds_read_b64_tr_b16 v[146:147], v151 offset:33792
    v_mfma_f32_16x16x32_bf16 v[164:167], v[168:171], v[100:103], v[164:167]
    v_mfma_f32_32x32x16_bf16 v[4:19], v[116:119], v[96:99], v[4:19]
    ds_read_b64_tr_b16 v[100:101], v148 offset:36864
    ds_read_b64_tr_b16 v[102:103], v148 offset:37888
    ds_read_b64_tr_b16 v[104:105], v149 offset:36864
    v_mfma_f32_32x32x16_bf16 v[20:35], v[120:123], v[96:99], v[20:35]
    ds_read_b64_tr_b16 v[106:107], v149 offset:37888
    ds_read_b64_tr_b16 v[108:109], v150 offset:36864
    ds_read_b64_tr_b16 v[110:111], v150 offset:37888
    s_lshl_b32 s48, s50, 11
    s_lshl_b32 s49, s26, 9
    s_add_u32 s60, s48, s49
    s_add_u32 s53, s60, 98304
    buffer_load_dwordx4 v[172:175], v176, s[44:47], s53 offen sc1
    v_mfma_f32_32x32x16_bf16 v[36:51], v[124:127], v[96:99], v[36:51]
    ds_read_b64_tr_b16 v[112:113], v151 offset:36864
    ds_read_b64_tr_b16 v[114:115], v151 offset:37888
    v_mfma_f32_32x32x16_bf16 v[52:67], v[128:131], v[96:99], v[52:67]
    v_mfma_f32_16x16x32_bf16 v[164:167], v[168:171], v[116:119], v[164:167]
    s_waitcnt lgkmcnt(8)
    v_mfma_f32_32x32x16_bf16 v[4:19], v[132:135], v[68:71], v[4:19]
    ds_read_b64_tr_b16 v[116:117], v148 offset:40960
    ds_read_b64_tr_b16 v[118:119], v148 offset:41984
    ds_read_b64_tr_b16 v[120:121], v149 offset:40960
    v_mfma_f32_32x32x16_bf16 v[20:35], v[136:139], v[68:71], v[20:35]
    ds_read_b64_tr_b16 v[122:123], v149 offset:41984
    ds_read_b64_tr_b16 v[124:125], v150 offset:40960
    ds_read_b64_tr_b16 v[126:127], v150 offset:41984
    v_mfma_f32_32x32x16_bf16 v[36:51], v[140:143], v[68:71], v[36:51]
    ds_read_b64_tr_b16 v[128:129], v151 offset:40960
    ds_read_b64_tr_b16 v[130:131], v151 offset:41984
    v_mfma_f32_32x32x16_bf16 v[52:67], v[144:147], v[68:71], v[52:67]
    v_mfma_f32_16x16x32_bf16 v[164:167], v[168:171], v[132:135], v[164:167]
    s_waitcnt lgkmcnt(8)
    v_mfma_f32_32x32x16_bf16 v[4:19], v[100:103], v[72:75], v[4:19]
    ds_read_b64_tr_b16 v[132:133], v148 offset:45056
    ds_read_b64_tr_b16 v[134:135], v148 offset:46080
    ds_read_b64_tr_b16 v[136:137], v149 offset:45056
    v_mfma_f32_32x32x16_bf16 v[20:35], v[104:107], v[72:75], v[20:35]
    ds_read_b64_tr_b16 v[138:139], v149 offset:46080
    ds_read_b64_tr_b16 v[140:141], v150 offset:45056
    ds_read_b64_tr_b16 v[142:143], v150 offset:46080
    v_mfma_f32_32x32x16_bf16 v[36:51], v[108:111], v[72:75], v[36:51]
    ds_read_b64_tr_b16 v[144:145], v151 offset:45056
    ds_read_b64_tr_b16 v[146:147], v151 offset:46080
    v_mfma_f32_32x32x16_bf16 v[52:67], v[112:115], v[72:75], v[52:67]
    v_mfma_f32_16x16x32_bf16 v[164:167], v[168:171], v[100:103], v[164:167]
    s_waitcnt vmcnt(1) lgkmcnt(0)
    s_barrier
    v_mfma_f32_32x32x16_bf16 v[4:19], v[116:119], v[76:79], v[4:19]
    ds_read_b128 v[84:87], v152 offset:4096
    ds_read_b128 v[88:91], v153 offset:4096
    ds_read_b128 v[92:95], v154 offset:4096
    v_mfma_f32_32x32x16_bf16 v[20:35], v[120:123], v[76:79], v[20:35]
    ds_read_b128 v[96:99], v155 offset:4096
    ds_read_b64_tr_b16 v[100:101], v148 offset:0
    ds_read_b64_tr_b16 v[102:103], v148 offset:1024
    v_mfma_f32_32x32x16_bf16 v[36:51], v[124:127], v[76:79], v[36:51]
    ds_read_b64_tr_b16 v[104:105], v149 offset:0
    ds_read_b64_tr_b16 v[106:107], v149 offset:1024
    ds_read_b64_tr_b16 v[108:109], v150 offset:0
    v_mfma_f32_32x32x16_bf16 v[52:67], v[128:131], v[76:79], v[52:67]
    ds_read_b64_tr_b16 v[110:111], v150 offset:1024
    ds_read_b64_tr_b16 v[112:113], v151 offset:0
    ds_read_b64_tr_b16 v[114:115], v151 offset:1024
    v_mfma_f32_16x16x32_bf16 v[164:167], v[168:171], v[116:119], v[164:167]
    v_mfma_f32_32x32x16_bf16 v[4:19], v[132:135], v[80:83], v[4:19]
    ds_read_b64_tr_b16 v[116:117], v148 offset:4096
    ds_read_b64_tr_b16 v[118:119], v148 offset:5120
    ds_read_b64_tr_b16 v[120:121], v149 offset:4096
    v_mfma_f32_32x32x16_bf16 v[20:35], v[136:139], v[80:83], v[20:35]
    ds_read_b64_tr_b16 v[122:123], v149 offset:5120
    ds_read_b64_tr_b16 v[124:125], v150 offset:4096
    ds_read_b64_tr_b16 v[126:127], v150 offset:5120
    v_mfma_f32_32x32x16_bf16 v[36:51], v[140:143], v[80:83], v[36:51]
    ds_read_b64_tr_b16 v[128:129], v151 offset:4096
    ds_read_b64_tr_b16 v[130:131], v151 offset:5120
    v_mfma_f32_32x32x16_bf16 v[52:67], v[144:147], v[80:83], v[52:67]
    v_mfma_f32_16x16x32_bf16 v[164:167], v[168:171], v[132:135], v[164:167]
    s_waitcnt lgkmcnt(8)
    v_mfma_f32_32x32x16_bf16 v[4:19], v[100:103], v[84:87], v[4:19]
    ds_read_b64_tr_b16 v[132:133], v148 offset:8192
    ds_read_b64_tr_b16 v[134:135], v148 offset:9216
    ds_read_b64_tr_b16 v[136:137], v149 offset:8192
    v_mfma_f32_32x32x16_bf16 v[20:35], v[104:107], v[84:87], v[20:35]
    ds_read_b64_tr_b16 v[138:139], v149 offset:9216
    ds_read_b64_tr_b16 v[140:141], v150 offset:8192
    ds_read_b64_tr_b16 v[142:143], v150 offset:9216
    v_mfma_f32_32x32x16_bf16 v[36:51], v[108:111], v[84:87], v[36:51]
    ds_read_b64_tr_b16 v[144:145], v151 offset:8192
    ds_read_b64_tr_b16 v[146:147], v151 offset:9216
    v_mfma_f32_32x32x16_bf16 v[52:67], v[112:115], v[84:87], v[52:67]
    v_mfma_f32_16x16x32_bf16 v[164:167], v[168:171], v[100:103], v[164:167]
    s_waitcnt lgkmcnt(8)
    v_mfma_f32_32x32x16_bf16 v[4:19], v[116:119], v[88:91], v[4:19]
    ds_read_b64_tr_b16 v[100:101], v148 offset:12288
    ds_read_b64_tr_b16 v[102:103], v148 offset:13312
    ds_read_b64_tr_b16 v[104:105], v149 offset:12288
    v_mfma_f32_32x32x16_bf16 v[20:35], v[120:123], v[88:91], v[20:35]
    ds_read_b64_tr_b16 v[106:107], v149 offset:13312
    ds_read_b64_tr_b16 v[108:109], v150 offset:12288
    ds_read_b64_tr_b16 v[110:111], v150 offset:13312
    v_mfma_f32_32x32x16_bf16 v[36:51], v[124:127], v[88:91], v[36:51]
    ds_read_b64_tr_b16 v[112:113], v151 offset:12288
    ds_read_b64_tr_b16 v[114:115], v151 offset:13312
    v_mfma_f32_32x32x16_bf16 v[52:67], v[128:131], v[88:91], v[52:67]
    v_mfma_f32_16x16x32_bf16 v[164:167], v[168:171], v[116:119], v[164:167]
    s_waitcnt lgkmcnt(8)
    v_mfma_f32_32x32x16_bf16 v[4:19], v[132:135], v[92:95], v[4:19]
    v_mfma_f32_32x32x16_bf16 v[20:35], v[136:139], v[92:95], v[20:35]
    v_mfma_f32_32x32x16_bf16 v[36:51], v[140:143], v[92:95], v[36:51]
    v_mfma_f32_32x32x16_bf16 v[52:67], v[144:147], v[92:95], v[52:67]
    v_mfma_f32_16x16x32_bf16 v[164:167], v[168:171], v[132:135], v[164:167]
    s_waitcnt lgkmcnt(0)
    v_mfma_f32_32x32x16_bf16 v[4:19], v[100:103], v[96:99], v[4:19]
    v_mfma_f32_32x32x16_bf16 v[20:35], v[104:107], v[96:99], v[20:35]
    v_mfma_f32_32x32x16_bf16 v[36:51], v[108:111], v[96:99], v[36:51]
    v_mfma_f32_32x32x16_bf16 v[52:67], v[112:115], v[96:99], v[52:67]
    v_mfma_f32_16x16x32_bf16 v[164:167], v[168:171], v[100:103], v[164:167]
    v_and_b32 v178, 15, v1
    v_lshlrev_b32 v178, 2, v178
    v_add_u32 v178, s55, v178
    v_lshlrev_b32 v179, 4, v182
    v_add_u32 v179, s55, v179
    s_waitcnt vmcnt(0)
    v_readfirstlane_b32 s28, v184
    v_readfirstlane_b32 s29, v185
    ds_write_b32 v178, v164
    ds_write_b32 v178, v165 offset:64
    s_cmp_lg_u32 s29, 0
    s_cbranch_scc1 L_have_42
    s_mov_b32 s56, 262144
    v_mov_b32 v181, 0
L_tag_45:
    buffer_load_dwordx2 v[184:185], v181, s[40:43], 0 offen offset:128 sc1
    s_waitcnt vmcnt(0)
    v_readfirstlane_b32 s28, v184
    v_readfirstlane_b32 s29, v185
    s_sub_u32 s56, s56, 1
    s_cmp_lg_u32 s29, 0
    s_cbranch_scc1 L_tout_46
    s_sleep 4
    s_cmp_lg_u32 s56, 0
    s_cbranch_scc1 L_tag_45
L_tout_46:
L_have_42:
    s_not_b32 s49, s28
    s_mov_b32 s56, 262144
L_again_43:
    v_cmpx_eq_u32 vcc, s28, v173
    v_cmpx_eq_u32 vcc, s49, v175
    s_sub_u32 s56, s56, 1
    s_cmp_eq_u64 vcc, -1
    s_mov_b64 exec, -1
    s_cbranch_scc1 L_ok_44
    s_sleep 4
    buffer_load_dwordx4 v[172:175], v176, s[44:47], s53 offen sc1
    s_cmp_lg_u32 s56, 0
    s_waitcnt vmcnt(0)
    s_cbranch_scc1 L_again_43
L_ok_44:
    v_mul_f32 v174, s57, v174
    s_waitcnt lgkmcnt(0)
    s_barrier
    s_mov_b32 s40, s24
    s_mov_b32 s41, s25
    s_mov_b32 s42, 0x780000
    s_mov_b32 s43, 0x20000
    v_subrev_u32 v153, 49152, v179
    v_xor_b32 v153, 8192, v153
    v_subrev_u32 v154, 49152, v179
    v_xor_b32 v154, 16384, v154
    v_subrev_u32 v155, 49152, v179
    v_xor_b32 v155, 24576, v155
    ds_read_b128 v[68:71], v179 offset:0
    ds_read_b128 v[72:75], v179 offset:32
    ds_read_b128 v[76:79], v179 offset:64
    ds_read_b128 v[80:83], v179 offset:96
    ds_read_b128 v[84:87], v153 offset:49152
    ds_read_b128 v[88:91], v153 offset:49184
    ds_read_b128 v[92:95], v153 offset:49216
    ds_read_b128 v[96:99], v153 offset:49248
    ds_read_b128 v[100:103], v154 offset:49152
    ds_read_b128 v[104:107], v154 offset:49184
    ds_read_b128 v[108:111], v154 offset:49216
    ds_read_b128 v[112:115], v154 offset:49248
    ds_read_b128 v[116:119], v155 offset:49152
    ds_read_b128 v[120:123], v155 offset:49184
    ds_read_b128 v[124:127], v155 offset:49216
    ds_read_b128 v[128:131], v155 offset:49248
    s_lshl_b32 s48, s51, 19
    s_add_u32 s60, s60, s48
    s_xor_b32 s48, s26, 0
    s_lshl_b32 s48, s48, 17
    s_add_u32 s53, s48, s60
    s_add_u32 s52, s53, 65536
    s_waitcnt lgkmcnt(14)
    v_pk_fma_f32 v[4:5], v[172:173], v[68:69], v[4:5] op_sel_hi:[0,1,1] neg_lo:[1,0,0] neg_hi:[1,0,0]
    v_pk_fma_f32 v[6:7], v[172:173], v[70:71], v[6:7] op_sel_hi:[0,1,1] neg_lo:[1,0,0] neg_hi:[1,0,0]
    v_pk_fma_f32 v[8:9], v[172:173], v[72:73], v[8:9] op_sel_hi:[0,1,1] neg_lo:[1,0,0] neg_hi:[1,0,0]
    v_pk_fma_f32 v[10:11], v[172:173], v[74:75], v[10:11] op_sel_hi:[0,1,1] neg_lo:[1,0,0] neg_hi:[1,0,0]
    v_pk_mul_f32 v[4:5], v[4:5], v[174:175] op_sel_hi:[1,0]
    v_pk_mul_f32 v[6:7], v[6:7], v[174:175] op_sel_hi:[1,0]
    v_pk_mul_f32 v[8:9], v[8:9], v[174:175] op_sel_hi:[1,0]
    v_pk_mul_f32 v[10:11], v[10:11], v[174:175] op_sel_hi:[1,0]
    v_cvt_pk_bf16_f32 v184, v4, v5
    v_cvt_pk_bf16_f32 v185, v6, v7
    v_cvt_pk_bf16_f32 v186, v8, v9
    v_cvt_pk_bf16_f32 v187, v10, v11
    buffer_store_dwordx4 v[184:187], v177, s[40:43], s53 offen sc1
    s_waitcnt lgkmcnt(12)
    v_pk_fma_f32 v[12:13], v[172:173], v[76:77], v[12:13] op_sel_hi:[0,1,1] neg_lo:[1,0,0] neg_hi:[1,0,0]
    v_pk_fma_f32 v[14:15], v[172:173], v[78:79], v[14:15] op_sel_hi:[0,1,1] neg_lo:[1,0,0] neg_hi:[1,0,0]
    v_pk_fma_f32 v[16:17], v[172:173], v[80:81], v[16:17] op_sel_hi:[0,1,1] neg_lo:[1,0,0] neg_hi:[1,0,0]
    v_pk_fma_f32 v[18:19], v[172:173], v[82:83], v[18:19] op_sel_hi:[0,1,1] neg_lo:[1,0,0] neg_hi:[1,0,0]
    v_pk_mul_f32 v[12:13], v[12:13], v[174:175] op_sel_hi:[1,0]
    v_pk_mul_f32 v[14:15], v[14:15], v[174:175] op_sel_hi:[1,0]
    v_pk_mul_f32 v[16:17], v[16:17], v[174:175] op_sel_hi:[1,0]
    v_pk_mul_f32 v[18:19], v[18:19], v[174:175] op_sel_hi:[1,0]
    v_cvt_pk_bf16_f32 v188, v12, v13
    v_cvt_pk_bf16_f32 v189, v14, v15
    v_cvt_pk_bf16_f32 v190, v16, v17
    v_cvt_pk_bf16_f32 v191, v18, v19
    buffer_store_dwordx4 v[188:191], v177, s[40:43], s52 offen sc1
    s_xor_b32 s48, s26, 1
    s_lshl_b32 s48, s48, 17
    s_add_u32 s53, s48, s60
    s_add_u32 s52, s53, 65536
    s_waitcnt lgkmcnt(10)
    v_pk_fma_f32 v[20:21], v[172:173], v[84:85], v[20:21] op_sel_hi:[0,1,1] neg_lo:[1,0,0] neg_hi:[1,0,0]
    v_pk_fma_f32 v[22:23], v[172:173], v[86:87], v[22:23] op_sel_hi:[0,1,1] neg_lo:[1,0,0] neg_hi:[1,0,0]
    v_pk_fma_f32 v[24:25], v[172:173], v[88:89], v[24:25] op_sel_hi:[0,1,1] neg_lo:[1,0,0] neg_hi:[1,0,0]
    v_pk_fma_f32 v[26:27], v[172:173], v[90:91], v[26:27] op_sel_hi:[0,1,1] neg_lo:[1,0,0] neg_hi:[1,0,0]
    v_pk_mul_f32 v[20:21], v[20:21], v[174:175] op_sel_hi:[1,0]
    v_pk_mul_f32 v[22:23], v[22:23], v[174:175] op_sel_hi:[1,0]
    v_pk_mul_f32 v[24:25], v[24:25], v[174:175] op_sel_hi:[1,0]
    v_pk_mul_f32 v[26:27], v[26:27], v[174:175] op_sel_hi:[1,0]
    v_cvt_pk_bf16_f32 v184, v20, v21
    v_cvt_pk_bf16_f32 v185, v22, v23
    v_cvt_pk_bf16_f32 v186, v24, v25
    v_cvt_pk_bf16_f32 v187, v26, v27
    buffer_store_dwordx4 v[184:187], v177, s[40:43], s53 offen sc1
    s_waitcnt lgkmcnt(8)
    v_pk_fma_f32 v[28:29], v[172:173], v[92:93], v[28:29] op_sel_hi:[0,1,1] neg_lo:[1,0,0] neg_hi:[1,0,0]
    v_pk_fma_f32 v[30:31], v[172:173], v[94:95], v[30:31] op_sel_hi:[0,1,1] neg_lo:[1,0,0] neg_hi:[1,0,0]
    v_pk_fma_f32 v[32:33], v[172:173], v[96:97], v[32:33] op_sel_hi:[0,1,1] neg_lo:[1,0,0] neg_hi:[1,0,0]
    v_pk_fma_f32 v[34:35], v[172:173], v[98:99], v[34:35] op_sel_hi:[0,1,1] neg_lo:[1,0,0] neg_hi:[1,0,0]
    v_pk_mul_f32 v[28:29], v[28:29], v[174:175] op_sel_hi:[1,0]
    v_pk_mul_f32 v[30:31], v[30:31], v[174:175] op_sel_hi:[1,0]
    v_pk_mul_f32 v[32:33], v[32:33], v[174:175] op_sel_hi:[1,0]
    v_pk_mul_f32 v[34:35], v[34:35], v[174:175] op_sel_hi:[1,0]
    v_cvt_pk_bf16_f32 v188, v28, v29
    v_cvt_pk_bf16_f32 v189, v30, v31
    v_cvt_pk_bf16_f32 v190, v32, v33
    v_cvt_pk_bf16_f32 v191, v34, v35
    buffer_store_dwordx4 v[188:191], v177, s[40:43], s52 offen sc1
    s_xor_b32 s48, s26, 2
    s_lshl_b32 s48, s48, 17
    s_add_u32 s53, s48, s60
    s_add_u32 s52, s53, 65536
    s_waitcnt lgkmcnt(6)
    v_pk_fma_f32 v[36:37], v[172:173], v[100:101], v[36:37] op_sel_hi:[0,1,1] neg_lo:[1,0,0] neg_hi:[1,0,0]
    v_pk_fma_f32 v[38:39], v[172:173], v[102:103], v[38:39] op_sel_hi:[0,1,1] neg_lo:[1,0,0] neg_hi:[1,0,0]
    v_pk_fma_f32 v[40:41], v[172:173], v[104:105], v[40:41] op_sel_hi:[0,1,1] neg_lo:[1,0,0] neg_hi:[1,0,0]
    v_pk_fma_f32 v[42:43], v[172:173], v[106:107], v[42:43] op_sel_hi:[0,1,1] neg_lo:[1,0,0] neg_hi:[1,0,0]
    v_pk_mul_f32 v[36:37], v[36:37], v[174:175] op_sel_hi:[1,0]
    v_pk_mul_f32 v[38:39], v[38:39], v[174:175] op_sel_hi:[1,0]
    v_pk_mul_f32 v[40:41], v[40:41], v[174:175] op_sel_hi:[1,0]
    v_pk_mul_f32 v[42:43], v[42:43], v[174:175] op_sel_hi:[1,0]
    v_cvt_pk_bf16_f32 v184, v36, v37
    v_cvt_pk_bf16_f32 v185, v38, v39
    v_cvt_pk_bf16_f32 v186, v40, v41
    v_cvt_pk_bf16_f32 v187, v42, v43
    buffer_store_dwordx4 v[184:187], v177, s[40:43], s53 offen sc1
    s_waitcnt lgkmcnt(4)
    v_pk_fma_f32 v[44:45], v[172:173], v[108:109], v[44:45] op_sel_hi:[0,1,1] neg_lo:[1,0,0] neg_hi:[1,0,0]
    v_pk_fma_f32 v[46:47], v[172:173], v[110:111], v[46:47] op_sel_hi:[0,1,1] neg_lo:[1,0,0] neg_hi:[1,0,0]
    v_pk_fma_f32 v[48:49], v[172:173], v[112:113], v[48:49] op_sel_hi:[0,1,1] neg_lo:[1,0,0] neg_hi:[1,0,0]
    v_pk_fma_f32 v[50:51], v[172:173], v[114:115], v[50:51] op_sel_hi:[0,1,1] neg_lo:[1,0,0] neg_hi:[1,0,0]
    v_pk_mul_f32 v[44:45], v[44:45], v[174:175] op_sel_hi:[1,0]
    v_pk_mul_f32 v[46:47], v[46:47], v[174:175] op_sel_hi:[1,0]
    v_pk_mul_f32 v[48:49], v[48:49], v[174:175] op_sel_hi:[1,0]
    v_pk_mul_f32 v[50:51], v[50:51], v[174:175] op_sel_hi:[1,0]
    v_cvt_pk_bf16_f32 v188, v44, v45
    v_cvt_pk_bf16_f32 v189, v46, v47
    v_cvt_pk_bf16_f32 v190, v48, v49
    v_cvt_pk_bf16_f32 v191, v50, v51
    buffer_store_dwordx4 v[188:191], v177, s[40:43], s52 offen sc1
    s_xor_b32 s48, s26, 3
    s_lshl_b32 s48, s48, 17
    s_add_u32 s53, s48, s60
    s_add_u32 s52, s53, 65536
    s_waitcnt lgkmcnt(2)
    v_pk_fma_f32 v[52:53], v[172:173], v[116:117], v[52:53] op_sel_hi:[0,1,1] neg_lo:[1,0,0] neg_hi:[1,0,0]
    v_pk_fma_f32 v[54:55], v[172:173], v[118:119], v[54:55] op_sel_hi:[0,1,1] neg_lo:[1,0,0] neg_hi:[1,0,0]
    v_pk_fma_f32 v[56:57], v[172:173], v[120:121], v[56:57] op_sel_hi:[0,1,1] neg_lo:[1,0,0] neg_hi:[1,0,0]
    v_pk_fma_f32 v[58:59], v[172:173], v[122:123], v[58:59] op_sel_hi:[0,1,1] neg_lo:[1,0,0] neg_hi:[1,0,0]
    v_pk_mul_f32 v[52:53], v[52:53], v[174:175] op_sel_hi:[1,0]
    v_pk_mul_f32 v[54:55], v[54:55], v[174:175] op_sel_hi:[1,0]
    v_pk_mul_f32 v[56:57], v[56:57], v[174:175] op_sel_hi:[1,0]
    v_pk_mul_f32 v[58:59], v[58:59], v[174:175] op_sel_hi:[1,0]
    v_cvt_pk_bf16_f32 v184, v52, v53
    v_cvt_pk_bf16_f32 v185, v54, v55
    v_cvt_pk_bf16_f32 v186, v56, v57
    v_cvt_pk_bf16_f32 v187, v58, v59
    buffer_store_dwordx4 v[184:187], v177, s[40:43], s53 offen sc1
    s_waitcnt lgkmcnt(0)
    v_pk_fma_f32 v[60:61], v[172:173], v[124:125], v[60:61] op_sel_hi:[0,1,1] neg_lo:[1,0,0] neg_hi:[1,0,0]
    v_pk_fma_f32 v[62:63], v[172:173], v[126:127], v[62:63] op_sel_hi:[0,1,1] neg_lo:[1,0,0] neg_hi:[1,0,0]
    v_pk_fma_f32 v[64:65], v[172:173], v[128:129], v[64:65] op_sel_hi:[0,1,1] neg_lo:[1,0,0] neg_hi:[1,0,0]
    v_pk_fma_f32 v[66:67], v[172:173], v[130:131], v[66:67] op_sel_hi:[0,1,1] neg_lo:[1,0,0] neg_hi:[1,0,0]
    v_pk_mul_f32 v[60:61], v[60:61], v[174:175] op_sel_hi:[1,0]
    v_pk_mul_f32 v[62:63], v[62:63], v[174:175] op_sel_hi:[1,0]
    v_pk_mul_f32 v[64:65], v[64:65], v[174:175] op_sel_hi:[1,0]
    v_pk_mul_f32 v[66:67], v[66:67], v[174:175] op_sel_hi:[1,0]
    v_cvt_pk_bf16_f32 v188, v60, v61
    v_cvt_pk_bf16_f32 v189, v62, v63
    v_cvt_pk_bf16_f32 v190, v64, v65
    v_cvt_pk_bf16_f32 v191, v66, v67
    buffer_store_dwordx4 v[188:191], v177, s[40:43], s52 offen sc1
L_att_3:
    s_mov_b32 s32, s24
    s_mov_b32 s33, s25
    s_mov_b32 s34, 0x780000
    s_mov_b32 s35, 0x20000
    s_add_u32 s36, s24, 0xf00000
    s_addc_u32 s37, s25, 0
    s_mov_b32 s38, 0x280000
    s_mov_b32 s39, 0x20000
    s_add_u32 s40, s24, 0x1180000
    s_addc_u32 s41, s25, 0
    s_mov_b32 s42, 0x40000
    s_mov_b32 s43, 0x20000
    s_and_b32 s44, s27, 7
    s_lshl_b32 s44, s44, 2
    s_lshr_b32 s46, s27, 6
    s_add_u32 s44, s44, s46
    s_lshr_b32 s45, s26, 1
    s_and_b32 s54, s44, 1
    s_lshr_b32 s46, s44, 1
    s_mul_i32 s49, s46, 5
    s_lshl_b32 s53, s49, 15
    s_mul_i32 s46, s54, 98304
    s_lshl_b32 s47, s54, 3
    s_add_u32 s47, s47, 65536
    v_and_b32 v203, 31, v1
    v_lshrrev_b32 v204, 5, v1
    v_lshlrev_b32 v185, 4, v1
    v_lshlrev_b32 v199, 4, v203
    v_lshl_add_u32 v189, v204, 15, v199
    v_add_u32 v189, s46, v189
    v_add_u32 v190, s47, v199
    v_add_u32 v191, 2048, v189
    v_add_u32 v192, 1536, v189
    v_add_u32 v193, 65536, v185
    s_lshl_b32 s55, s26, 10
    s_add_u32 s55, s55, s53
    s_add_u32 s55, s55, 2619392
    s_add_u32 s56, s55, 2621440
    s_mul_i32 s58, s26, 6480
    s_lshr_b32 s46, s49, 4
    s_add_u32 s47, s49, 4
    s_lshr_b32 s47, s47, 4
    s_sub_u32 s47, s47, s46
    s_lshl_b32 s47, s47, 11
    s_lshl_b32 s57, s46, 11
    s_add_u32 s57, s57, 32768
    v_bfe_u32 v200, v1, 4, 1
    v_mul_lo_u32 v200, v200, s47
    v_add_u32 v201, 1, v204
    v_mul_u32_u24 v201, 10240, v201
    v_and_b32 v202, 15, v1
    v_lshlrev_b32 v202, 7, v202
    v_add3_u32 v186, v200, v201, v202
    s_bfe_u32 s52, s27, 0x30003
    s_lshl_b32 s46, s52, 8
    v_and_b32 v202, 1, v1
    v_lshlrev_b32 v202, 7, v202
    v_add3_u32 v187, v200, v202, s46
    s_lshl_b32 s52, s52, 12
    s_and_b32 s47, s26, 1
    s_lshl_b32 s47, s47, 11
    s_add_u32 s52, s52, s47
    s_lshl_b32 s47, s45, 10
    s_sub_u32 s48, s52, s47
    s_add_u32 s48, s48, 1024
    s_add_u32 s48, s48, s53
    s_add_u32 s52, s52, s47
    s_add_u32 s51, s52, s53
    s_mov_b32 s60, 0
    s_mov_b32 s61, -1
    s_mov_b32 s62, -1
    s_mov_b32 s63, 0
    s_mov_b32 s50, 0
    v_mov_b32 v184, 0xdddddddd
    v_mov_b32 v68, 0x3f80
    v_mov_b32 v69, 0
    v_mov_b32 v70, 0
    v_mov_b32 v71, 0
    v_min_u32 v200, 320, v185
    v_add_u32 v200, s58, v200
    ds_write_b128 v200, v[68:71] offset:6144
    ds_write_b128 v200, v[68:71] offset:32064
    ds_write_b128 v200, v[68:71] offset:57984
    s_lshl_b32 s47, s54, 3
    s_add_u32 s47, s47, 2048
    v_add_u32 v201, s47, v199
    v_mov_b32 v202, 6144
    v_cndmask_b32 v197, v201, v202, s[60:61]
    s_lshl_b32 s46, s45, 9
    v_add_u32 v201, s46, v201
    v_cndmask_b32 v195, v201, v202, s[60:61]
    s_lshl_b32 s46, s45, 10
    v_add_u32 v194, s46, v185
    v_bfe_u32 v200, v1, 2, 2
    v_lshl_add_u32 v200, v204, 3, v200
    v_lshlrev_b32 v200, 4, v200
    v_and_b32 v201, 1, v1
    v_lshl_add_u32 v198, v201, 9, v200
    v_bfe_u32 v201, v1, 1, 1
    v_lshl_add_u32 v198, v201, 3, v198
    v_add_u32 v198, 3072, v198
    v_add_u32 v196, s46, v198
    s_add_u32 s47, s47, 3072
    v_add_u32 v200, s47, v200
    v_and_b32 v201, 0x13, v1
    v_cmp_eq_u32 vcc, 16, v201
    s_lshl_b32 s46, s45, 9
    v_add_u32 v202, s46, v200
    v_cndmask_b32 v198, v198, v200, vcc
    v_cndmask_b32 v196, v196, v202, vcc
    v_cmp_eq_u32 vcc, 17, v201
    v_mov_b32 v202, 6144
    s_nop 0
    v_cndmask_b32 v198, v198, v202, vcc
    v_cndmask_b32 v196, v196, v202, vcc
    v_cmp_lt_u32 vcc, 17, v201
    v_mov_b32 v202, 6152
    s_nop 0
    v_cndmask_b32 v198, v198, v202, vcc
    v_cndmask_b32 v196, v196, v202, vcc
    v_mov_b32 v4, 0
    v_mov_b32 v5, 0
    v_mov_b32 v6, 0
    v_mov_b32 v7, 0
    v_mov_b32 v8, 0
    v_mov_b32 v9, 0
    v_mov_b32 v10, 0
    v_mov_b32 v11, 0
    v_mov_b32 v12, 0
    v_mov_b32 v13, 0
    v_mov_b32 v14, 0
    v_mov_b32 v15, 0
    v_mov_b32 v16, 0
    v_mov_b32 v17, 0
    v_mov_b32 v18, 0
    v_mov_b32 v19, 0
    v_mov_b32 v20, 0
    v_mov_b32 v21, 0
    v_mov_b32 v22, 0
    v_mov_b32 v23, 0
    v_mov_b32 v24, 0
    v_mov_b32 v25, 0
    v_mov_b32 v26, 0
    v_mov_b32 v27, 0
    v_mov_b32 v28, 0
    v_mov_b32 v29, 0
    v_mov_b32 v30, 0
    v_mov_b32 v31, 0
    v_mov_b32 v32, 0
    v_mov_b32 v33, 0
    v_mov_b32 v34, 0
    v_mov_b32 v35, 0
    v_mov_b32 v36, 0
    v_mov_b32 v37, 0
    v_mov_b32 v38, 0
    v_mov_b32 v39, 0
    v_mov_b32 v40, 0
    v_mov_b32 v41, 0
    v_mov_b32 v42, 0
    v_mov_b32 v43, 0
    v_mov_b32 v44, 0
    v_mov_b32 v45, 0
    v_mov_b32 v46, 0
    v_mov_b32 v47, 0
    v_mov_b32 v48, 0
    v_mov_b32 v49, 0
    v_mov_b32 v50, 0
    v_mov_b32 v51, 0
    v_mov_b32 v52, 0
    v_mov_b32 v53, 0
    v_mov_b32 v54, 0
    v_mov_b32 v55, 0
    v_mov_b32 v56, 0
    v_mov_b32 v57, 0
    v_mov_b32 v58, 0
    v_mov_b32 v59, 0
    v_mov_b32 v60, 0
    v_mov_b32 v61, 0
    v_mov_b32 v62, 0
    v_mov_b32 v63, 0
    v_mov_b32 v64, 0
    v_mov_b32 v65, 0
    v_mov_b32 v66, 0
    v_mov_b32 v67, 0
    v_mov_b32 v172, 0
    v_mov_b32 v180, 0
    v_mov_b32 v173, 0
    v_mov_b32 v181, 0
    v_mov_b32 v174, 0
    v_mov_b32 v182, 0
    v_mov_b32 v175, 0
    v_mov_b32 v183, 0
    s_waitcnt vmcnt(0)
    s_barrier
    s_cmp_lg_u32 s26, 0
    s_cbranch_scc1 L_pub_47
    v_mov_b32 v200, 0
    v_mov_b32 v84, s28
    v_mov_b32 v85, s29
    s_mov_b64 exec, 1
    buffer_store_dwordx2 v[84:85], v200, s[40:43], s30 offen sc1
    s_mov_b64 exec, -1
L_pub_47:
    s_cmp_lg_u32 s26, 0
    s_cbranch_scc1 L_ow_48
    s_mov_b32 s49, 262144
L_poll_49:
    buffer_load_dwordx2 v[84:85], v186, s[40:43], s57 offen offset:0 sc1
    buffer_load_dwordx2 v[86:87], v187, s[40:43], s57 offen offset:0 sc1
    s_waitcnt vmcnt(0)
    v_cmpx_eq_u64 vcc, s[28:29], v[84:85]
    v_cmpx_eq_u64 vcc, s[28:29], v[86:87]
    s_sub_u32 s49, s49, 1
    s_cmp_eq_u64 vcc, -1
    s_mov_b64 exec, -1
    s_cbranch_scc1 L_pout_50
    s_sleep 4
    s_cmp_lg_u32 s49, 0
    s_cbranch_scc1 L_poll_49
L_pout_50:
    s_lshl_b32 s46, s27, 7
    s_add_u32 s46, s46, 65536
    s_cmp_lg_u32 s26, 0
    s_cbranch_scc1 L_go_51
    v_mov_b32 v200, 0
    v_mov_b32 v84, s28
    v_mov_b32 v85, s29
    s_mov_b64 exec, 1
    buffer_store_dwordx2 v[84:85], v200, s[40:43], s46 offen sc1
    s_mov_b64 exec, -1
L_go_51:
L_ow_48:
    s_barrier
    s_add_u32 m0, s58, 0
    s_nop 0
    buffer_load_dwordx4 v191, s[32:35], s55 offen offset:0 sc1 lds
    buffer_load_dwordx4 v192, s[32:35], s55 offen offset:1024 sc1 lds
    buffer_load_dwordx4 v193, s[32:35], s55 offen offset:2048 sc1 lds
    s_add_u32 m0, s58, 3072
    s_add_u32 s55, s55, 4096
    buffer_load_dwordx4 v191, s[32:35], s56 offen offset:0 sc1 lds
    buffer_load_dwordx4 v192, s[32:35], s56 offen offset:1024 sc1 lds
    buffer_load_dwordx4 v193, s[32:35], s56 offen offset:2048 sc1 lds
    s_add_u32 s56, s56, 4096
    s_mov_b32 s57, 65536
    buffer_load_dwordx4 v[132:135], v189, s[32:35], s51 offen offset:0 sc1
    buffer_load_dwordx2 v[148:149], v190, s[32:35], s51 offen offset:0 sc1
    buffer_load_dwordx4 v[136:139], v189, s[32:35], s51 offen offset:512 sc1
    buffer_load_dwordx2 v[150:151], v190, s[32:35], s51 offen offset:512 sc1
    buffer_load_dwordx4 v[140:143], v189, s[32:35], s48 offen offset:0 sc1
    buffer_load_dwordx2 v[152:153], v190, s[32:35], s48 offen offset:0 sc1
    buffer_load_dwordx4 v[144:147], v189, s[32:35], s48 offen offset:512 sc1
    buffer_load_dwordx2 v[154:155], v190, s[32:35], s48 offen offset:512 sc1
    s_add_u32 m0, s58, 25920
    s_nop 0
    buffer_load_dwordx4 v191, s[32:35], s55 offen offset:0 sc1 lds
    buffer_load_dwordx4 v192, s[32:35], s55 offen offset:1024 sc1 lds
    buffer_load_dwordx4 v193, s[32:35], s55 offen offset:2048 sc1 lds
    s_add_u32 m0, s58, 28992
    s_add_u32 s55, s55, 4096
    buffer_load_dwordx4 v191, s[32:35], s56 offen offset:0 sc1 lds
    buffer_load_dwordx4 v192, s[32:35], s56 offen offset:1024 sc1 lds
    buffer_load_dwordx4 v193, s[32:35], s56 offen offset:2048 sc1 lds
    s_add_u32 s56, s56, 4096
    v_mov_b32 v186, v194
    v_mov_b32 v187, v195
    v_mov_b32 v188, v196
    s_mov_b32 s48, 0
    s_waitcnt vmcnt(6) lgkmcnt(0)
    s_barrier
    ds_read_b128 v[160:163], v185
    ds_read_b64 v[166:167], v197
    ds_read_b128 v[156:159], v186
    ds_read_b64 v[164:165], v187
    ds_read_b64_tr_b16 v[168:169], v188 offset:0
    ds_read_b64_tr_b16 v[170:171], v188 offset:64
    ds_read_b64_tr_b16 v[176:177], v188 offset:256
    ds_read_b64_tr_b16 v[178:179], v188 offset:320
    v_cndmask_b32 v148, v148, 0, s[60:61]
    v_cndmask_b32 v149, v149, 0, s[60:61]
    v_cndmask_b32 v150, v150, 0, s[60:61]
    v_cndmask_b32 v151, v151, 0, s[60:61]
    v_cndmask_b32 v152, v152, 0, s[60:61]
    v_cndmask_b32 v153, v153, 0, s[60:61]
    v_cndmask_b32 v154, v154, 0, s[60:61]
    v_cndmask_b32 v155, v155, 0, s[60:61]
    s_waitcnt lgkmcnt(6)
    v_mfma_f32_32x32x16_bf16 v[68:83], v[160:163], v[140:143], 0
    v_mfma_f32_32x32x8_bf16 v[68:83], v[166:167], v[152:153], v[68:83]
    v_mfma_f32_32x32x16_bf16 v[84:99], v[160:163], v[144:147], 0
    v_mfma_f32_32x32x8_bf16 v[84:99], v[166:167], v[154:155], v[84:99]
    v_mfma_f32_32x32x16_bf16 v[100:115], v[160:163], v[132:135], 0
    v_mfma_f32_32x32x8_bf16 v[100:115], v[166:167], v[148:149], v[100:115]
    v_mfma_f32_32x32x16_bf16 v[116:131], v[160:163], v[136:139], 0
    v_mfma_f32_32x32x8_bf16 v[116:131], v[166:167], v[150:151], v[116:131]
    s_nop 7
    v_max3_f32 v199, v68, v69, v70
    v_max3_f32 v199, v199, v71, v72
    v_max3_f32 v199, v199, v73, v74
    v_max3_f32 v199, v199, v75, v76
    v_max3_f32 v199, v199, v77, v78
    v_max3_f32 v199, v199, v79, v80
    v_max3_f32 v199, v199, v81, v82
    v_max_f32 v199, v199, v83
    v_xor_b32 v199, 0x80000000, v199
    v_lshrrev_b32 v199, 16, v199
    v_cndmask_b32 v152, v152, v199, s[60:61]
    s_waitcnt lgkmcnt(0)
    v_mfma_f32_32x32x16_bf16 v[68:83], v[156:159], v[140:143], 0
    v_mfma_f32_32x32x8_bf16 v[68:83], v[164:165], v[152:153], v[68:83]
    v_max3_f32 v199, v84, v85, v86
    v_max3_f32 v199, v199, v87, v88
    v_max3_f32 v199, v199, v89, v90
    v_max3_f32 v199, v199, v91, v92
    v_max3_f32 v199, v199, v93, v94
    v_max3_f32 v199, v199, v95, v96
    v_max3_f32 v199, v199, v97, v98
    v_max_f32 v199, v199, v99
    v_xor_b32 v199, 0x80000000, v199
    v_lshrrev_b32 v199, 16, v199
    v_cndmask_b32 v154, v154, v199, s[60:61]
    v_max3_f32 v199, v100, v101, v102
    v_max3_f32 v199, v199, v103, v104
    v_max3_f32 v199, v199, v105, v106
    v_max3_f32 v199, v199, v107, v108
    v_max3_f32 v199, v199, v109, v110
    v_max3_f32 v199, v199, v111, v112
    v_max3_f32 v199, v199, v113, v114
    v_max_f32 v199, v199, v115
    v_xor_b32 v199, 0x80000000, v199
    v_lshrrev_b32 v199, 16, v199
    v_cndmask_b32 v148, v148, v199, s[60:61]
    v_max3_f32 v199, v116, v117, v118
    v_max3_f32 v199, v199, v119, v120
    v_max3_f32 v199, v199, v121, v122
    v_max3_f32 v199, v199, v123, v124
    v_max3_f32 v199, v199, v125, v126
    v_max3_f32 v199, v199, v127, v128
    v_max3_f32 v199, v199, v129, v130
    v_max_f32 v199, v199, v131
    v_xor_b32 v199, 0x80000000, v199
    v_lshrrev_b32 v199, 16, v199
    v_cndmask_b32 v150, v150, v199, s[60:61]
    v_mov_b32 v116, 0
    v_mov_b32 v117, 0
    v_mov_b32 v118, 0
    v_mov_b32 v119, 0
    v_mov_b32 v120, 0
    v_mov_b32 v121, 0
    v_mov_b32 v122, 0
    v_mov_b32 v123, 0
    v_mov_b32 v124, 0
    v_mov_b32 v125, 0
    v_mov_b32 v126, 0
    v_mov_b32 v127, 0
    v_mov_b32 v128, 0
    v_mov_b32 v129, 0
    v_mov_b32 v130, 0
    v_mov_b32 v131, 0
    s_add_u32 s57, s58, 51840
    s_mov_b32 m0, s57
    s_mov_b32 s49, 8
.p2align 6
L_loop_52:
    v_mfma_f32_32x32x16_bf16 v[84:99], v[156:159], v[144:147], 0
    ds_read_b128 v[160:163], v186 offset:6480
    v_exp_f32 v68, v68
    v_exp_f32 v69, v69
    v_exp_f32 v70, v70
    v_exp_f32 v71, v71
    v_smfmac_f32_32x32x32_bf16 v[20:35], v[172:175], v[116:123], v184
    ds_read_b64 v[166:167], v187 offset:6480
    v_exp_f32 v72, v72
    v_exp_f32 v73, v73
    v_mfma_f32_32x32x8_bf16 v[84:99], v[164:165], v[154:155], v[84:99]
    buffer_load_dwordx4 v191, s[32:35], s55 offen offset:0 sc1 lds
    v_exp_f32 v74, v74
    v_exp_f32 v75, v75
    v_exp_f32 v76, v76
    v_exp_f32 v77, v77
    v_exp_f32 v78, v78
    v_smfmac_f32_32x32x32_bf16 v[20:35], v[180:183], v[124:131], v184
    buffer_load_dwordx4 v192, s[32:35], s55 offen offset:1024 sc1 lds
    v_exp_f32 v79, v79
    v_exp_f32 v80, v80
    v_exp_f32 v81, v81
    v_exp_f32 v82, v82
    v_exp_f32 v83, v83
    v_mfma_f32_32x32x16_bf16 v[100:115], v[156:159], v[132:135], 0
    ds_read_b64_tr_b16 v[172:173], v188 offset:6480
    v_exp_f32 v84, v84
    v_exp_f32 v85, v85
    v_exp_f32 v86, v86
    v_exp_f32 v87, v87
    v_smfmac_f32_32x32x32_bf16 v[36:51], v[168:171], v[68:75], v184
    ds_read_b64_tr_b16 v[174:175], v188 offset:6544
    v_exp_f32 v88, v88
    v_exp_f32 v89, v89
    v_mfma_f32_32x32x8_bf16 v[100:115], v[164:165], v[148:149], v[100:115]
    ds_read_b64_tr_b16 v[180:181], v188 offset:6736
    v_exp_f32 v90, v90
    v_exp_f32 v91, v91
    v_exp_f32 v92, v92
    v_exp_f32 v93, v93
    v_exp_f32 v94, v94
    v_smfmac_f32_32x32x32_bf16 v[36:51], v[176:179], v[76:83], v184
    ds_read_b64_tr_b16 v[182:183], v188 offset:6800
    v_exp_f32 v95, v95
    v_exp_f32 v96, v96
    v_exp_f32 v97, v97
    v_exp_f32 v98, v98
    v_exp_f32 v99, v99
    v_mfma_f32_32x32x16_bf16 v[116:131], v[156:159], v[136:139], 0
    buffer_load_dwordx4 v193, s[32:35], s55 offen offset:2048 sc1 lds
    s_add_u32 m0, s57, 3072
    s_add_u32 s55, s55, 4096
    v_exp_f32 v100, v100
    v_exp_f32 v101, v101
    v_exp_f32 v102, v102
    v_exp_f32 v103, v103
    v_smfmac_f32_32x32x32_bf16 v[52:67], v[168:171], v[84:91], v184
    buffer_load_dwordx4 v191, s[32:35], s56 offen offset:0 sc1 lds
    v_exp_f32 v104, v104
    v_exp_f32 v105, v105
    v_mfma_f32_32x32x8_bf16 v[116:131], v[164:165], v[150:151], v[116:131]
    buffer_load_dwordx4 v192, s[32:35], s56 offen offset:1024 sc1 lds
    v_exp_f32 v106, v106
    v_exp_f32 v107, v107
    v_exp_f32 v108, v108
    v_exp_f32 v109, v109
    v_exp_f32 v110, v110
    v_smfmac_f32_32x32x32_bf16 v[52:67], v[176:179], v[92:99], v184
    buffer_load_dwordx4 v193, s[32:35], s56 offen offset:2048 sc1 lds
    s_add_u32 s56, s56, 4096
    v_exp_f32 v111, v111
    v_exp_f32 v112, v112
    v_exp_f32 v113, v113
    v_exp_f32 v114, v114
    v_exp_f32 v115, v115
    s_waitcnt lgkmcnt(0)
    v_mfma_f32_32x32x16_bf16 v[68:83], v[160:163], v[140:143], 0
    v_exp_f32 v116, v116
    v_exp_f32 v117, v117
    v_exp_f32 v118, v118
    v_exp_f32 v119, v119
    v_smfmac_f32_32x32x32_bf16 v[4:19], v[168:171], v[100:107], v184
    v_exp_f32 v120, v120
    v_exp_f32 v121, v121
    v_mfma_f32_32x32x8_bf16 v[68:83], v[166:167], v[152:153], v[68:83]
    v_exp_f32 v122, v122
    v_exp_f32 v123, v123
    v_exp_f32 v124, v124
    v_exp_f32 v125, v125
    v_exp_f32 v126, v126
    v_smfmac_f32_32x32x32_bf16 v[4:19], v[176:179], v[108:115], v184
    v_exp_f32 v127, v127
    v_exp_f32 v128, v128
    v_exp_f32 v129, v129
    v_exp_f32 v130, v130
    v_exp_f32 v131, v131
    v_mfma_f32_32x32x16_bf16 v[84:99], v[160:163], v[144:147], 0
    ds_read_b128 v[156:159], v186 offset:12960
    v_exp_f32 v68, v68
    v_exp_f32 v69, v69
    v_exp_f32 v70, v70
    v_exp_f32 v71, v71
    v_smfmac_f32_32x32x32_bf16 v[20:35], v[168:171], v[116:123], v184
    ds_read_b64 v[164:165], v187 offset:12960
    v_exp_f32 v72, v72
    v_exp_f32 v73, v73
    v_mfma_f32_32x32x8_bf16 v[84:99], v[166:167], v[154:155], v[84:99]
    v_exp_f32 v74, v74
    v_exp_f32 v75, v75
    v_exp_f32 v76, v76
    v_exp_f32 v77, v77
    v_exp_f32 v78, v78
    v_smfmac_f32_32x32x32_bf16 v[20:35], v[176:179], v[124:131], v184
    v_exp_f32 v79, v79
    v_exp_f32 v80, v80
    v_exp_f32 v81, v81
    v_exp_f32 v82, v82
    v_exp_f32 v83, v83
    v_mfma_f32_32x32x16_bf16 v[100:115], v[160:163], v[132:135], 0
    ds_read_b64_tr_b16 v[168:169], v188 offset:12960
    v_exp_f32 v84, v84
    v_exp_f32 v85, v85
    v_exp_f32 v86, v86
    v_exp_f32 v87, v87
    v_smfmac_f32_32x32x32_bf16 v[36:51], v[172:175], v[68:75], v184
    ds_read_b64_tr_b16 v[170:171], v188 offset:13024
    v_exp_f32 v88, v88
    v_exp_f32 v89, v89
    v_mfma_f32_32x32x8_bf16 v[100:115], v[166:167], v[148:149], v[100:115]
    ds_read_b64_tr_b16 v[176:177], v188 offset:13216
    v_exp_f32 v90, v90
    v_exp_f32 v91, v91
    v_exp_f32 v92, v92
    v_exp_f32 v93, v93
    v_exp_f32 v94, v94
    v_smfmac_f32_32x32x32_bf16 v[36:51], v[180:183], v[76:83], v184
    ds_read_b64_tr_b16 v[178:179], v188 offset:13280
    v_exp_f32 v95, v95
    v_exp_f32 v96, v96
    v_exp_f32 v97, v97
    v_exp_f32 v98, v98
    v_exp_f32 v99, v99
    v_mfma_f32_32x32x16_bf16 v[116:131], v[160:163], v[136:139], 0
    v_exp_f32 v100, v100
    v_exp_f32 v101, v101
    v_exp_f32 v102, v102
    v_exp_f32 v103, v103
    v_smfmac_f32_32x32x32_bf16 v[52:67], v[172:175], v[84:91], v184
    v_exp_f32 v104, v104
    v_exp_f32 v105, v105
    v_mfma_f32_32x32x8_bf16 v[116:131], v[166:167], v[150:151], v[116:131]
    v_exp_f32 v106, v106
    v_exp_f32 v107, v107
    v_exp_f32 v108, v108
    v_exp_f32 v109, v109
    v_exp_f32 v110, v110
    v_smfmac_f32_32x32x32_bf16 v[52:67], v[180:183], v[92:99], v184
    v_exp_f32 v111, v111
    v_exp_f32 v112, v112
    v_exp_f32 v113, v113
    v_exp_f32 v114, v114
    v_exp_f32 v115, v115
    s_waitcnt lgkmcnt(0)
    v_mfma_f32_32x32x16_bf16 v[68:83], v[156:159], v[140:143], 0
    v_exp_f32 v116, v116
    v_exp_f32 v117, v117
    v_exp_f32 v118, v118
    v_exp_f32 v119, v119
    v_smfmac_f32_32x32x32_bf16 v[4:19], v[172:175], v[100:107], v184
    v_exp_f32 v120, v120
    v_exp_f32 v121, v121
    v_mfma_f32_32x32x8_bf16 v[68:83], v[164:165], v[152:153], v[68:83]
    v_exp_f32 v122, v122
    v_exp_f32 v123, v123
    v_exp_f32 v124, v124
    v_exp_f32 v125, v125
    v_exp_f32 v126, v126
    v_smfmac_f32_32x32x32_bf16 v[4:19], v[180:183], v[108:115], v184
    v_exp_f32 v127, v127
    v_exp_f32 v128, v128
    v_exp_f32 v129, v129
    v_exp_f32 v130, v130
    v_exp_f32 v131, v131
    v_mfma_f32_32x32x16_bf16 v[84:99], v[156:159], v[144:147], 0
    ds_read_b128 v[160:163], v186 offset:19440
    v_exp_f32 v68, v68
    v_exp_f32 v69, v69
    v_exp_f32 v70, v70
    v_exp_f32 v71, v71
    v_smfmac_f32_32x32x32_bf16 v[20:35], v[172:175], v[116:123], v184
    ds_read_b64 v[166:167], v187 offset:19440
    v_exp_f32 v72, v72
    v_exp_f32 v73, v73
    v_mfma_f32_32x32x8_bf16 v[84:99], v[164:165], v[154:155], v[84:99]
    v_exp_f32 v74, v74
    v_exp_f32 v75, v75
    v_exp_f32 v76, v76
    v_exp_f32 v77, v77
    v_exp_f32 v78, v78
    v_smfmac_f32_32x32x32_bf16 v[20:35], v[180:183], v[124:131], v184
    v_exp_f32 v79, v79
    v_exp_f32 v80, v80
    v_exp_f32 v81, v81
    v_exp_f32 v82, v82
    v_exp_f32 v83, v83
    v_mfma_f32_32x32x16_bf16 v[100:115], v[156:159], v[132:135], 0
    ds_read_b64_tr_b16 v[172:173], v188 offset:19440
    v_exp_f32 v84, v84
    v_exp_f32 v85, v85
    v_exp_f32 v86, v86
    v_exp_f32 v87, v87
    v_smfmac_f32_32x32x32_bf16 v[36:51], v[168:171], v[68:75], v184
    ds_read_b64_tr_b16 v[174:175], v188 offset:19504
    v_exp_f32 v88, v88
    v_exp_f32 v89, v89
    v_mfma_f32_32x32x8_bf16 v[100:115], v[164:165], v[148:149], v[100:115]
    ds_read_b64_tr_b16 v[180:181], v188 offset:19696
    v_exp_f32 v90, v90
    v_exp_f32 v91, v91
    v_exp_f32 v92, v92
    v_exp_f32 v93, v93
    v_exp_f32 v94, v94
    v_smfmac_f32_32x32x32_bf16 v[36:51], v[176:179], v[76:83], v184
    ds_read_b64_tr_b16 v[182:183], v188 offset:19760
    v_exp_f32 v95, v95
    v_exp_f32 v96, v96
    v_exp_f32 v97, v97
    v_exp_f32 v98, v98
    v_exp_f32 v99, v99
    v_mfma_f32_32x32x16_bf16 v[116:131], v[156:159], v[136:139], 0
    v_exp_f32 v100, v100
    v_exp_f32 v101, v101
    v_exp_f32 v102, v102
    v_exp_f32 v103, v103
    v_smfmac_f32_32x32x32_bf16 v[52:67], v[168:171], v[84:91], v184
    v_exp_f32 v104, v104
    v_exp_f32 v105, v105
    v_mfma_f32_32x32x8_bf16 v[116:131], v[164:165], v[150:151], v[116:131]
    v_exp_f32 v106, v106
    v_exp_f32 v107, v107
    v_exp_f32 v108, v108
    v_exp_f32 v109, v109
    v_exp_f32 v110, v110
    v_smfmac_f32_32x32x32_bf16 v[52:67], v[176:179], v[92:99], v184
    v_exp_f32 v111, v111
    v_exp_f32 v112, v112
    v_exp_f32 v113, v113
    v_exp_f32 v114, v114
    v_exp_f32 v115, v115
    s_waitcnt lgkmcnt(0)
    v_mfma_f32_32x32x16_bf16 v[68:83], v[160:163], v[140:143], 0
    v_exp_f32 v116, v116
    v_exp_f32 v117, v117
    v_exp_f32 v118, v118
    v_exp_f32 v119, v119
    v_smfmac_f32_32x32x32_bf16 v[4:19], v[168:171], v[100:107], v184
    v_exp_f32 v120, v120
    v_exp_f32 v121, v121
    v_mfma_f32_32x32x8_bf16 v[68:83], v[166:167], v[152:153], v[68:83]
    v_exp_f32 v122, v122
    v_exp_f32 v123, v123
    v_exp_f32 v124, v124
    v_exp_f32 v125, v125
    v_exp_f32 v126, v126
    v_smfmac_f32_32x32x32_bf16 v[4:19], v[176:179], v[108:115], v184
    v_exp_f32 v127, v127
    v_exp_f32 v128, v128
    v_exp_f32 v129, v129
    v_exp_f32 v130, v130
    v_exp_f32 v131, v131
    s_add_u32 s57, s48, s58
    s_add_u32 s48, s48, 25920
    s_cmp_ge_u32 s48, 77760
    s_cselect_b32 s48, 0, s48
    v_add_u32 v186, s48, v194
    v_add_u32 v187, s48, v195
    v_add_u32 v188, s48, v196
    s_cmp_le_u32 s49, 3
    s_cselect_b32 s55, 0x7f000000, s55
    s_cselect_b32 s56, 0x7f000000, s56
    s_mov_b32 m0, s57
    s_waitcnt vmcnt(6)
    s_barrier
    v_mfma_f32_32x32x16_bf16 v[84:99], v[160:163], v[144:147], 0
    ds_read_b128 v[156:159], v186 offset:0
    v_exp_f32 v68, v68
    v_exp_f32 v69, v69
    v_exp_f32 v70, v70
    v_exp_f32 v71, v71
    v_smfmac_f32_32x32x32_bf16 v[20:35], v[168:171], v[116:123], v184
    ds_read_b64 v[164:165], v187 offset:0
    v_exp_f32 v72, v72
    v_exp_f32 v73, v73
    v_mfma_f32_32x32x8_bf16 v[84:99], v[166:167], v[154:155], v[84:99]
    v_exp_f32 v74, v74
    v_exp_f32 v75, v75
    v_exp_f32 v76, v76
    v_exp_f32 v77, v77
    v_exp_f32 v78, v78
    v_smfmac_f32_32x32x32_bf16 v[20:35], v[176:179], v[124:131], v184
    v_exp_f32 v79, v79
    v_exp_f32 v80, v80
    v_exp_f32 v81, v81
    v_exp_f32 v82, v82
    v_exp_f32 v83, v83
    v_mfma_f32_32x32x16_bf16 v[100:115], v[160:163], v[132:135], 0
    ds_read_b64_tr_b16 v[168:169], v188 offset:0
    v_exp_f32 v84, v84
    v_exp_f32 v85, v85
    v_exp_f32 v86, v86
    v_exp_f32 v87, v87
    v_smfmac_f32_32x32x32_bf16 v[36:51], v[172:175], v[68:75], v184
    ds_read_b64_tr_b16 v[170:171], v188 offset:64
    v_exp_f32 v88, v88
    v_exp_f32 v89, v89
    v_mfma_f32_32x32x8_bf16 v[100:115], v[166:167], v[148:149], v[100:115]
    ds_read_b64_tr_b16 v[176:177], v188 offset:256
    v_exp_f32 v90, v90
    v_exp_f32 v91, v91
    v_exp_f32 v92, v92
    v_exp_f32 v93, v93
    v_exp_f32 v94, v94
    v_smfmac_f32_32x32x32_bf16 v[36:51], v[180:183], v[76:83], v184
    ds_read_b64_tr_b16 v[178:179], v188 offset:320
    v_exp_f32 v95, v95
    v_exp_f32 v96, v96
    v_exp_f32 v97, v97
    v_exp_f32 v98, v98
    v_exp_f32 v99, v99
    v_mfma_f32_32x32x16_bf16 v[116:131], v[160:163], v[136:139], 0
    v_exp_f32 v100, v100
    v_exp_f32 v101, v101
    v_exp_f32 v102, v102
    v_exp_f32 v103, v103
    v_smfmac_f32_32x32x32_bf16 v[52:67], v[172:175], v[84:91], v184
    v_exp_f32 v104, v104
    v_exp_f32 v105, v105
    v_mfma_f32_32x32x8_bf16 v[116:131], v[166:167], v[150:151], v[116:131]
    v_exp_f32 v106, v106
    v_exp_f32 v107, v107
    v_exp_f32 v108, v108
    v_exp_f32 v109, v109
    v_exp_f32 v110, v110
    v_smfmac_f32_32x32x32_bf16 v[52:67], v[180:183], v[92:99], v184
    v_exp_f32 v111, v111
    v_exp_f32 v112, v112
    v_exp_f32 v113, v113
    v_exp_f32 v114, v114
    v_exp_f32 v115, v115
    s_waitcnt lgkmcnt(0)
    v_mfma_f32_32x32x16_bf16 v[68:83], v[156:159], v[140:143], 0
    v_exp_f32 v116, v116
    v_exp_f32 v117, v117
    v_exp_f32 v118, v118
    v_exp_f32 v119, v119
    v_smfmac_f32_32x32x32_bf16 v[4:19], v[172:175], v[100:107], v184
    v_exp_f32 v120, v120
    v_exp_f32 v121, v121
    v_mfma_f32_32x32x8_bf16 v[68:83], v[164:165], v[152:153], v[68:83]
    v_exp_f32 v122, v122
    v_exp_f32 v123, v123
    v_exp_f32 v124, v124
    v_exp_f32 v125, v125
    v_exp_f32 v126, v126
    v_smfmac_f32_32x32x32_bf16 v[4:19], v[180:183], v[108:115], v184
    v_exp_f32 v127, v127
    v_exp_f32 v128, v128
    v_exp_f32 v129, v129
    v_exp_f32 v130, v130
    v_exp_f32 v131, v131
    s_sub_u32 s49, s49, 1
    s_cmp_lg_u32 s49, 0
    s_cbranch_scc1 L_loop_52
    s_setprio 3
    v_smfmac_f32_32x32x32_bf16 v[20:35], v[172:175], v[116:123], v184
    v_add_u32 v186, s58, v185
    s_waitcnt vmcnt(0)
    ds_write_b128 v186, v[36:39] offset:0
    ds_write_b128 v186, v[40:43] offset:1024
    ds_write_b128 v186, v[44:47] offset:2048
    v_smfmac_f32_32x32x32_bf16 v[20:35], v[180:183], v[124:131], v184
    ds_write_b128 v186, v[52:55] offset:3072
    ds_write_b128 v186, v[56:59] offset:4096
    ds_write_b128 v186, v[60:63] offset:5120
    s_xor_b32 s47, s26, 2
    s_mul_i32 s47, s47, 6480
    v_add_u32 v188, s47, v185
    v_lshlrev_b32 v199, 4, v203
    v_lshl_add_u32 v194, v204, 15, v199
    v_lshlrev_b32 v195, 3, v203
    v_mov_b32 v199, 0x7f000000
    v_cndmask_b32 v195, v195, v199, s[60:61]
    s_lshl_b32 s46, s44, 16
    s_add_u32 s55, s46, s52
    s_lshl_b32 s46, s44, 14
    s_lshr_b32 s56, s52, 1
    s_add_u32 s56, s56, s46
    s_add_u32 s56, s56, 2097152
    s_lshl_b32 s30, s52, 2
    s_lshl_b32 s46, s44, 7
    s_add_u32 s30, s30, s46
    s_add_u32 s30, s30, 131072
    s_waitcnt lgkmcnt(0)
    s_barrier
    ds_read_b128 v[76:79], v188 offset:2048
    ds_read_b128 v[68:71], v188 offset:0
    ds_read_b128 v[72:75], v188 offset:1024
    ds_read_b128 v[92:95], v188 offset:5120
    ds_read_b128 v[84:87], v188 offset:3072
    ds_read_b128 v[88:91], v188 offset:4096
    s_waitcnt lgkmcnt(3)
    v_add_f32 v12, v12, v76
    v_add_f32 v13, v13, v77
    v_add_f32 v14, v14, v78
    v_add_f32 v15, v15, v79
    v_add_f32 v4, v4, v68
    v_add_f32 v5, v5, v69
    v_add_f32 v6, v6, v70
    v_add_f32 v7, v7, v71
    v_add_f32 v8, v8, v72
    v_add_f32 v9, v9, v73
    v_add_f32 v10, v10, v74
    v_add_f32 v11, v11, v75
    s_waitcnt lgkmcnt(0)
    v_add_f32 v28, v28, v92
    v_add_f32 v29, v29, v93
    v_add_f32 v30, v30, v94
    v_add_f32 v31, v31, v95
    v_add_f32 v20, v20, v84
    v_add_f32 v21, v21, v85
    v_add_f32 v22, v22, v86
    v_add_f32 v23, v23, v87
    v_add_f32 v24, v24, v88
    v_add_f32 v25, v25, v89
    v_add_f32 v26, v26, v90
    v_add_f32 v27, v27, v91
L_fin_53:
    v_mov_b32 v120, v12
    v_mov_b32 v118, v12
    v_mov_b32 v121, v28
    v_mov_b32 v119, v28
    s_nop 1
    v_permlane32_swap_b32 v120, v118
    v_permlane32_swap_b32 v121, v119
    v_rcp_f32 v116, v118
    v_rcp_f32 v117, v119
    v_mul_f32 v4, v4, v116
    v_mul_f32 v5, v5, v116
    v_mul_f32 v6, v6, v116
    v_mul_f32 v7, v7, v116
    v_mul_f32 v8, v8, v116
    v_mul_f32 v9, v9, v116
    v_mul_f32 v10, v10, v116
    v_mul_f32 v11, v11, v116
    v_mul_f32 v12, v12, v116
    v_mul_f32 v13, v13, v116
    v_mul_f32 v14, v14, v116
    v_mul_f32 v15, v15, v116
    v_cvt_pk_bf16_f32 v100, v4, v5
    v_cvt_pk_bf16_f32 v101, v6, v7
    v_cvt_pk_bf16_f32 v102, v8, v9
    v_cvt_pk_bf16_f32 v103, v10, v11
    v_cvt_pk_bf16_f32 v104, v12, v13
    v_cvt_pk_bf16_f32 v105, v14, v15
    buffer_store_dwordx4 v[100:103], v194, s[36:39], s55 offen offset:0 sc1
    buffer_store_dwordx2 v[104:105], v195, s[36:39], s56 offen offset:0 sc1
    v_mul_f32 v20, v20, v117
    v_mul_f32 v21, v21, v117
    v_mul_f32 v22, v22, v117
    v_mul_f32 v23, v23, v117
    v_mul_f32 v24, v24, v117
    v_mul_f32 v25, v25, v117
    v_mul_f32 v26, v26, v117
    v_mul_f32 v27, v27, v117
    v_mul_f32 v28, v28, v117
    v_mul_f32 v29, v29, v117
    v_mul_f32 v30, v30, v117
    v_mul_f32 v31, v31, v117
    v_cvt_pk_bf16_f32 v108, v20, v21
    v_cvt_pk_bf16_f32 v109, v22, v23
    v_cvt_pk_bf16_f32 v110, v24, v25
    v_cvt_pk_bf16_f32 v111, v26, v27
    v_cvt_pk_bf16_f32 v112, v28, v29
    v_cvt_pk_bf16_f32 v113, v30, v31
    buffer_store_dwordx4 v[108:111], v194, s[36:39], s55 offen offset:512 sc1
    buffer_store_dwordx2 v[112:113], v195, s[36:39], s56 offen offset:256 sc1
    s_mov_b32 s47, 0x7f7fffff
    v_add_f32 v202, abs(v4), abs(v20)
    v_add_f32 v202, v202, abs(v5)
    v_add_f32 v202, v202, abs(v21)
    v_add_f32 v202, v202, abs(v6)
    v_add_f32 v202, v202, abs(v22)
    v_add_f32 v202, v202, abs(v7)
    v_add_f32 v202, v202, abs(v23)
    v_add_f32 v202, v202, abs(v8)
    v_add_f32 v202, v202, abs(v24)
    v_add_f32 v202, v202, abs(v9)
    v_add_f32 v202, v202, abs(v25)
    v_add_f32 v202, v202, abs(v10)
    v_add_f32 v202, v202, abs(v26)
    v_add_f32 v202, v202, abs(v11)
    v_add_f32 v202, v202, abs(v27)
    v_add_f32 v202, v202, abs(v12)
    v_add_f32 v202, v202, abs(v28)
    v_add_f32 v202, v202, abs(v13)
    v_add_f32 v202, v202, abs(v29)
    v_add_f32 v202, v202, abs(v14)
    v_add_f32 v202, v202, abs(v30)
    v_add_f32 v202, v202, abs(v15)
    v_add_f32 v202, v202, abs(v31)
    v_cmpx_ge_f32 vcc, s47, v202
    v_cmpx_le_f32 vcc, 0x2b800000, v118
    v_cmpx_ge_f32 vcc, 0x5f800000, v118
    v_cmpx_le_f32 vcc, 0x2b800000, v119
    v_cmpx_ge_f32 vcc, 0x5f800000, v119
    s_cmp_eq_u64 vcc, -1
    s_mov_b64 exec, -1
    s_cselect_b32 s46, 1, 0
    s_or_b32 s46, s46, s50
    s_cmp_eq_u32 s46, 0
    s_cbranch_scc1 L_slow_54
    v_mov_b32 v199, 0
    v_mov_b32 v68, s28
    v_mov_b32 v69, s29
    s_mov_b64 exec, 1
    s_waitcnt vmcnt(0)
    buffer_store_dwordx2 v[68:69], v199, s[40:43], s30 offen sc1
    s_endpgm
L_slow_54:
    s_mov_b32 s50, 1
    s_add_u32 s53, s53, 2619392
    s_mov_b32 s46, s53
    s_mov_b32 s49, 64
    s_add_u32 s57, s58, 25920
    v_add_u32 v186, s57, v185
    v_add_u32 v187, s57, v197
    v_add_u32 v188, s57, v198
    v_mov_b32 v201, 0xff800000
    v_mov_b32 v202, 0xff800000
    s_waitcnt vmcnt(0)
    v_cndmask_b32 v148, v148, 0, s[60:61]
    v_cndmask_b32 v150, v150, 0, s[60:61]
L_mx_55:
    s_mov_b32 m0, s57
    s_add_u32 s47, s46, 2621440
    buffer_load_dwordx4 v191, s[32:35], s46 offen offset:0 sc1 lds
    buffer_load_dwordx4 v193, s[32:35], s46 offen offset:2048 sc1 lds
    s_waitcnt vmcnt(0)
    ds_read_b128 v[156:159], v186
    ds_read_b64 v[164:165], v187
    v_mov_b32 v199, 0x3f803f80
    s_waitcnt lgkmcnt(0)
    v_cndmask_b32 v164, v164, v199, s[60:61]
    v_cndmask_b32 v165, v165, v199, s[60:61]
    s_nop 1
    v_mfma_f32_32x32x16_bf16 v[68:83], v[156:159], v[132:135], 0
    v_mfma_f32_32x32x8_bf16 v[68:83], v[164:165], v[148:149], v[68:83]
    v_mfma_f32_32x32x16_bf16 v[84:99], v[156:159], v[136:139], 0
    v_mfma_f32_32x32x8_bf16 v[84:99], v[164:165], v[150:151], v[84:99]
    s_nop 15
    v_max3_f32 v201, v201, v68, v69
    v_max3_f32 v201, v201, v70, v71
    v_max3_f32 v201, v201, v72, v73
    v_max3_f32 v201, v201, v74, v75
    v_max3_f32 v201, v201, v76, v77
    v_max3_f32 v201, v201, v78, v79
    v_max3_f32 v201, v201, v80, v81
    v_max3_f32 v201, v201, v82, v83
    v_max3_f32 v202, v202, v84, v85
    v_max3_f32 v202, v202, v86, v87
    v_max3_f32 v202, v202, v88, v89
    v_max3_f32 v202, v202, v90, v91
    v_max3_f32 v202, v202, v92, v93
    v_max3_f32 v202, v202, v94, v95
    v_max3_f32 v202, v202, v96, v97
    v_max3_f32 v202, v202, v98, v99
    s_add_u32 s46, s46, 512
    s_sub_u32 s49, s49, 1
    s_cmp_lg_u32 s49, 0
    s_cbranch_scc1 L_mx_55
    v_mov_b32 v199, v201
    v_mov_b32 v200, v201
    s_nop 1
    v_permlane32_swap_b32 v199, v200
    s_nop 1
    v_max_f32 v201, v199, v200
    v_xor_b32 v201, 0x80000000, v201
    v_and_b32 v199, 0xffff0000, v201
    v_sub_f32 v201, v201, v199
    v_and_b32 v200, 0xffff0000, v201
    v_sub_f32 v201, v201, v200
    v_lshrrev_b32 v199, 16, v199
    v_or_b32 v199, v199, v200
    v_lshrrev_b32 v201, 16, v201
    v_cndmask_b32 v148, v148, v199, s[60:61]
    v_cndmask_b32 v149, v149, v201, s[60:61]
    v_mov_b32 v4, 0
    v_mov_b32 v5, 0
    v_mov_b32 v6, 0
    v_mov_b32 v7, 0
    v_mov_b32 v8, 0
    v_mov_b32 v9, 0
    v_mov_b32 v10, 0
    v_mov_b32 v11, 0
    v_mov_b32 v12, 0
    v_mov_b32 v13, 0
    v_mov_b32 v14, 0
    v_mov_b32 v15, 0
    v_mov_b32 v16, 0
    v_mov_b32 v17, 0
    v_mov_b32 v18, 0
    v_mov_b32 v19, 0
    v_mov_b32 v199, v202
    v_mov_b32 v200, v202
    s_nop 1
    v_permlane32_swap_b32 v199, v200
    s_nop 1
    v_max_f32 v202, v199, v200
    v_xor_b32 v202, 0x80000000, v202
    v_and_b32 v199, 0xffff0000, v202
    v_sub_f32 v202, v202, v199
    v_and_b32 v200, 0xffff0000, v202
    v_sub_f32 v202, v202, v200
    v_lshrrev_b32 v199, 16, v199
    v_or_b32 v199, v199, v200
    v_lshrrev_b32 v202, 16, v202
    v_cndmask_b32 v150, v150, v199, s[60:61]
    v_cndmask_b32 v151, v151, v202, s[60:61]
    v_mov_b32 v20, 0
    v_mov_b32 v21, 0
    v_mov_b32 v22, 0
    v_mov_b32 v23, 0
    v_mov_b32 v24, 0
    v_mov_b32 v25, 0
    v_mov_b32 v26, 0
    v_mov_b32 v27, 0
    v_mov_b32 v28, 0
    v_mov_b32 v29, 0
    v_mov_b32 v30, 0
    v_mov_b32 v31, 0
    v_mov_b32 v32, 0
    v_mov_b32 v33, 0
    v_mov_b32 v34, 0
    v_mov_b32 v35, 0
    s_mov_b32 s46, s53
    s_mov_b32 s49, 64
L_re_56:
    s_mov_b32 m0, s57
    s_add_u32 s47, s46, 2621440
    buffer_load_dwordx4 v191, s[32:35], s46 offen offset:0 sc1 lds
    buffer_load_dwordx4 v193, s[32:35], s46 offen offset:2048 sc1 lds
    s_add_u32 m0, s57, 3072
    s_nop 0
    buffer_load_dwordx4 v191, s[32:35], s47 offen offset:0 sc1 lds
    buffer_load_dwordx4 v193, s[32:35], s47 offen offset:2048 sc1 lds
    s_waitcnt vmcnt(0)
    ds_read_b128 v[156:159], v186
    ds_read_b64 v[164:165], v187
    ds_read_b64_tr_b16 v[168:169], v188 offset:0
    ds_read_b64_tr_b16 v[170:171], v188 offset:64
    ds_read_b64_tr_b16 v[176:177], v188 offset:256
    ds_read_b64_tr_b16 v[178:179], v188 offset:320
    v_mov_b32 v199, 0x3f803f80
    s_waitcnt lgkmcnt(0)
    v_cndmask_b32 v164, v164, v199, s[60:61]
    v_cndmask_b32 v165, v165, v199, s[60:61]
    s_nop 1
    v_mfma_f32_32x32x16_bf16 v[68:83], v[156:159], v[132:135], 0
    v_mfma_f32_32x32x8_bf16 v[68:83], v[164:165], v[148:149], v[68:83]
    v_mfma_f32_32x32x16_bf16 v[84:99], v[156:159], v[136:139], 0
    v_mfma_f32_32x32x8_bf16 v[84:99], v[164:165], v[150:151], v[84:99]
    s_nop 15
    v_exp_f32 v68, v68
    v_exp_f32 v69, v69
    v_exp_f32 v70, v70
    v_exp_f32 v71, v71
    v_exp_f32 v72, v72
    v_exp_f32 v73, v73
    v_exp_f32 v74, v74
    v_exp_f32 v75, v75
    v_exp_f32 v76, v76
    v_exp_f32 v77, v77
    v_exp_f32 v78, v78
    v_exp_f32 v79, v79
    v_exp_f32 v80, v80
    v_exp_f32 v81, v81
    v_exp_f32 v82, v82
    v_exp_f32 v83, v83
    v_exp_f32 v84, v84
    v_exp_f32 v85, v85
    v_exp_f32 v86, v86
    v_exp_f32 v87, v87
    v_exp_f32 v88, v88
    v_exp_f32 v89, v89
    v_exp_f32 v90, v90
    v_exp_f32 v91, v91
    v_exp_f32 v92, v92
    v_exp_f32 v93, v93
    v_exp_f32 v94, v94
    v_exp_f32 v95, v95
    v_exp_f32 v96, v96
    v_exp_f32 v97, v97
    v_exp_f32 v98, v98
    v_exp_f32 v99, v99
    s_nop 1
    v_smfmac_f32_32x32x32_bf16 v[4:19], v[168:171], v[68:75], v184
    v_smfmac_f32_32x32x32_bf16 v[4:19], v[176:179], v[76:83], v184
    v_smfmac_f32_32x32x32_bf16 v[20:35], v[168:171], v[84:91], v184
    v_smfmac_f32_32x32x32_bf16 v[20:35], v[176:179], v[92:99], v184
    s_add_u32 s46, s46, 512
    s_sub_u32 s49, s49, 1
    s_cmp_lg_u32 s49, 0
    s_nop 7
    s_cbranch_scc1 L_re_56
    s_nop 15
    s_branch L_fin_53
L_spare_4:
    s_waitcnt lgkmcnt(0)
    s_mov_b32 s32, s22
    s_mov_b32 s33, s23
    s_mov_b32 s34, 0x100
    s_mov_b32 s35, 0x20000
    s_mov_b32 s36, 262144
    v_mov_b32 v2, 0
L_tag_57:
    s_sleep 100
    buffer_load_dwordx2 v[4:5], v2, s[32:35], 0 offen offset:128 sc1
    s_waitcnt vmcnt(0)
    v_readfirstlane_b32 s28, v4
    v_readfirstlane_b32 s29, v5
    s_sub_u32 s36, s36, 1
    s_cmp_lg_u32 s29, 0
    s_cbranch_scc1 L_tout_58
    s_cmp_lg_u32 s36, 0
    s_cbranch_scc1 L_tag_57
L_tout_58:
    s_add_u32 s32, s24, 0x1180000
    s_addc_u32 s33, s25, 0
    s_mov_b32 s34, 0x40000
    s_mov_b32 s35, 0x20000
    s_mov_b32 s30, 32768
    s_cmp_lg_u32 s26, 0
    s_cbranch_scc1 L_ow_59
    s_mov_b32 s36, 262144
L_poll_60:
    buffer_load_dwordx2 v[4:5], v2, s[32:35], s30 offen offset:0 sc1
    s_waitcnt vmcnt(0)
    v_cmpx_eq_u64 vcc, s[28:29], v[4:5]
    s_sub_u32 s36, s36, 1
    s_cmp_eq_u64 vcc, -1
    s_mov_b64 exec, -1
    s_cbranch_scc1 L_pout_61
    s_sleep 16
    s_cmp_lg_u32 s36, 0
    s_cbranch_scc1 L_poll_60
L_pout_61:
L_ow_59:
    s_barrier
    s_mov_b32 s30, 0x7f000000
    s_branch L_att_3
L_bpart_5:
    v_mul_u32_u24 v229, 1296, v193
    v_lshl_add_u32 v229, v194, 3, v229
    s_lshl_b32 s52, s26, 5
    s_add_u32 s52, s52, s57
    s_add_u32 s52, s52, 14336
    v_add_u32 v229, s52, v229
    v_bfe_u32 v196, v1, 3, 1
    v_mul_u32_u24 v231, 20512, v196
    v_bfe_u32 v196, v1, 2, 1
    v_mul_u32_u24 v196, 1296, v196
    v_add_u32 v231, v231, v196
    v_lshrrev_b32 v196, 4, v1
    v_lshl_add_u32 v231, v196, 5, v231
    v_and_b32 v196, 3, v1
    v_lshl_add_u32 v231, v196, 3, v231
    s_lshl_b32 s52, s26, 7
    v_add_u32 v231, s52, v231
    v_lshlrev_b32 v199, 4, v1
    v_lshrrev_b32 v193, 4, v1
    v_bfe_u32 v194, v1, 2, 2
    v_lshl_add_u32 v195, v193, 3, v194
    v_lshlrev_b32 v195, 7, v195
    v_bfe_u32 v194, v1, 3, 2
    v_xor_b32 v194, s26, v194
    v_lshl_add_u32 v195, v194, 5, v195
    v_and_b32 v194, 3, v1
    v_lshl_add_u32 v195, v194, 3, v195
    v_add_u32 v184, s57, v195
    v_xor_b32 v185, 32, v184
    v_xor_b32 v186, 64, v184
    v_xor_b32 v187, 0x60, v184
    v_mul_u32_u24 v192, 10240, v193
    v_and_b32 v194, 15, v1
    v_lshl_add_u32 v192, v194, 4, v192
    s_bfe_u32 s52, s27, 0x20001
    s_mul_i32 s52, s52, 27
    s_lshr_b32 s53, s27, 3
    s_add_u32 s52, s52, s53
    s_lshr_b32 s58, s52, 2
    s_and_b32 s59, s52, 3
    s_and_b32 s53, s27, 1
    s_lshl_b32 s53, s53, 2
    s_add_u32 s59, s59, s53
    v_lshrrev_b32 v193, 3, v1
    v_mul_u32_u24 v193, 3456, v193
    v_bfe_u32 v194, v1, 4, 1
    v_lshlrev_b32 v194, 1, v194
    v_and_b32 v195, 7, v1
    v_xor_b32 v194, v194, v195
    v_xor_b32 v195, 0, v194
    v_lshl_add_u32 v188, v195, 4, v193
    v_xor_b32 v195, 4, v194
    v_lshl_add_u32 v189, v195, 4, v193
    v_add_u32 v189, 26624, v189
    v_xor_b32 v195, 0, v194
    v_lshl_add_u32 v190, v195, 4, v193
    v_add_u32 v190, 53248, v190
    v_xor_b32 v195, 4, v194
    v_lshl_add_u32 v191, v195, 4, v193
    v_add_u32 v191, 79872, v191
    s_mul_i32 s54, s26, 110592
    s_lshl_b32 s52, s58, 7
    s_add_u32 s54, s54, s52
    s_mul_i32 s55, s26, 40960
    s_mul_i32 s53, s59, 1280
    s_add_u32 s55, s55, s53
    s_mov_b32 s32, s12
    s_mov_b32 s33, s13
    s_mov_b32 s34, 0x6c0000
    s_mov_b32 s35, 0x20000
    s_add_u32 s48, s24, 0x1180000
    s_addc_u32 s49, s25, 0
    s_mov_b32 s50, 0x40000
    s_mov_b32 s51, 0x20000
    s_mov_b32 s62, 0xffff0000
    s_waitcnt vmcnt(0)
    s_add_u32 s36, s24, 0xa00000
    s_addc_u32 s37, s25, 0
    s_mov_b32 s38, 0x280000
    s_mov_b32 s39, 0x20000
    v_lshlrev_b32 v4, 16, v104
    v_and_b32 v5, s62, v104
    v_lshlrev_b32 v6, 16, v105
    v_and_b32 v7, s62, v105
    v_lshlrev_b32 v8, 16, v106
    v_and_b32 v9, s62, v106
    v_lshlrev_b32 v10, 16, v107
    v_and_b32 v11, s62, v107
    v_lshlrev_b32 v12, 16, v108
    v_and_b32 v13, s62, v108
    v_lshlrev_b32 v14, 16, v109
    v_and_b32 v15, s62, v109
    v_lshlrev_b32 v16, 16, v110
    v_and_b32 v17, s62, v110
    v_lshlrev_b32 v18, 16, v111
    v_and_b32 v19, s62, v111
    v_lshlrev_b32 v20, 16, v112
    v_and_b32 v21, s62, v112
    v_lshlrev_b32 v22, 16, v113
    v_and_b32 v23, s62, v113
    v_pk_add_f32 v[84:85], v[4:5], v[6:7]
    v_pk_add_f32 v[84:85], v[84:85], v[8:9]
    v_pk_add_f32 v[84:85], v[84:85], v[10:11]
    v_pk_add_f32 v[84:85], v[84:85], v[12:13]
    v_pk_add_f32 v[84:85], v[84:85], v[14:15]
    v_pk_add_f32 v[84:85], v[84:85], v[16:17]
    v_pk_add_f32 v[84:85], v[84:85], v[18:19]
    v_pk_add_f32 v[84:85], v[84:85], v[20:21]
    v_pk_add_f32 v[84:85], v[84:85], v[22:23]
    v_add_f32 v84, v84, v85
    s_nop 1
    v_add_f32_dpp v84, v84, v84 quad_perm:[1,0,3,2] row_mask:0xf bank_mask:0xf
    s_nop 1
    v_add_f32_dpp v84, v84, v84 quad_perm:[2,3,0,1] row_mask:0xf bank_mask:0xf
    s_nop 1
    v_add_f32_dpp v84, v84, v84 row_half_mirror row_mask:0xf bank_mask:0xf
    s_nop 1
    v_add_f32_dpp v84, v84, v84 row_mirror row_mask:0xf bank_mask:0xf
    v_mov_b32 v86, v84
    s_nop 1
    v_permlane16_swap_b32 v86, v84
    s_nop 0
    v_add_f32 v84, v84, v86
    v_mul_f32 v92, 0x3acccccd, v84
    v_mul_f32 v84, 0xbacccccd, v84
    v_pk_add_f32 v[4:5], v[4:5], v[84:85] op_sel_hi:[1,0]
    v_pk_add_f32 v[6:7], v[6:7], v[84:85] op_sel_hi:[1,0]
    v_pk_add_f32 v[8:9], v[8:9], v[84:85] op_sel_hi:[1,0]
    v_pk_add_f32 v[10:11], v[10:11], v[84:85] op_sel_hi:[1,0]
    v_pk_add_f32 v[12:13], v[12:13], v[84:85] op_sel_hi:[1,0]
    v_pk_add_f32 v[14:15], v[14:15], v[84:85] op_sel_hi:[1,0]
    v_pk_add_f32 v[16:17], v[16:17], v[84:85] op_sel_hi:[1,0]
    v_pk_add_f32 v[18:19], v[18:19], v[84:85] op_sel_hi:[1,0]
    v_pk_add_f32 v[20:21], v[20:21], v[84:85] op_sel_hi:[1,0]
    v_pk_add_f32 v[22:23], v[22:23], v[84:85] op_sel_hi:[1,0]
    v_pk_mul_f32 v[84:85], v[4:5], v[4:5]
    v_pk_fma_f32 v[84:85], v[6:7], v[6:7], v[84:85]
    v_pk_fma_f32 v[84:85], v[8:9], v[8:9], v[84:85]
    v_pk_fma_f32 v[84:85], v[10:11], v[10:11], v[84:85]
    v_pk_fma_f32 v[84:85], v[12:13], v[12:13], v[84:85]
    v_pk_fma_f32 v[84:85], v[14:15], v[14:15], v[84:85]
    v_pk_fma_f32 v[84:85], v[16:17], v[16:17], v[84:85]
    v_pk_fma_f32 v[84:85], v[18:19], v[18:19], v[84:85]
    v_pk_fma_f32 v[84:85], v[20:21], v[20:21], v[84:85]
    v_pk_fma_f32 v[84:85], v[22:23], v[22:23], v[84:85]
    v_add_f32 v84, v84, v85
    s_nop 1
    v_add_f32_dpp v84, v84, v84 quad_perm:[1,0,3,2] row_mask:0xf bank_mask:0xf
    s_nop 1
    v_add_f32_dpp v84, v84, v84 quad_perm:[2,3,0,1] row_mask:0xf bank_mask:0xf
    s_nop 1
    v_add_f32_dpp v84, v84, v84 row_half_mirror row_mask:0xf bank_mask:0xf
    s_nop 1
    v_add_f32_dpp v84, v84, v84 row_mirror row_mask:0xf bank_mask:0xf
    v_mov_b32 v86, v84
    s_nop 1
    v_permlane16_swap_b32 v86, v84
    s_nop 0
    v_add_f32 v84, v84, v86
    v_mov_b32 v86, 0x3727c5ac
    v_mul_f32 v84, 0x3acccccd, v84
    v_add_f32 v88, v84, v86
    v_rsq_f32 v88, v88
    s_nop 0
    v_mul_f32 v84, v84, v88
    v_fma_f32 v84, v84, v88, v86
    v_rsq_f32 v84, v84
    v_mov_b32 v93, v88
    v_lshrrev_b32 v194, 5, v1
    s_lshl_b32 s52, s26, 1
    v_add_u32 v194, s52, v194
    v_lshlrev_b32 v194, 3, v194
    ds_write_b64 v194, v[92:93] offset:14336
    v_mul_f32 v84, v84, v88
    v_pk_mul_f32 v[4:5], v[4:5], v[84:85] op_sel_hi:[1,0]
    v_pk_mul_f32 v[6:7], v[6:7], v[84:85] op_sel_hi:[1,0]
    v_pk_mul_f32 v[8:9], v[8:9], v[84:85] op_sel_hi:[1,0]
    v_pk_mul_f32 v[10:11], v[10:11], v[84:85] op_sel_hi:[1,0]
    v_pk_mul_f32 v[12:13], v[12:13], v[84:85] op_sel_hi:[1,0]
    v_pk_mul_f32 v[14:15], v[14:15], v[84:85] op_sel_hi:[1,0]
    v_pk_mul_f32 v[16:17], v[16:17], v[84:85] op_sel_hi:[1,0]
    v_pk_mul_f32 v[18:19], v[18:19], v[84:85] op_sel_hi:[1,0]
    v_pk_mul_f32 v[20:21], v[20:21], v[84:85] op_sel_hi:[1,0]
    v_pk_mul_f32 v[22:23], v[22:23], v[84:85] op_sel_hi:[1,0]
    v_cvt_pk_bf16_f32 v114, v4, v5
    v_cvt_pk_bf16_f32 v115, v6, v7
    v_cvt_pk_bf16_f32 v116, v8, v9
    v_cvt_pk_bf16_f32 v117, v10, v11
    v_cvt_pk_bf16_f32 v118, v12, v13
    v_cvt_pk_bf16_f32 v119, v14, v15
    v_cvt_pk_bf16_f32 v120, v16, v17
    v_cvt_pk_bf16_f32 v121, v18, v19
    v_cvt_pk_bf16_f32 v122, v20, v21
    v_cvt_pk_bf16_f32 v123, v22, v23
    ds_write_b64 v229, v[114:115] offset:2592
    ds_write_b64 v229, v[116:117] offset:2848
    ds_write_b64 v229, v[118:119] offset:3104
    ds_write_b64 v229, v[120:121] offset:3360
    ds_write_b64 v229, v[122:123] offset:3616
    s_mul_i32 s63, s27, 10240
    s_lshl_b32 s64, s26, 10
    s_add_u32 s63, s63, s64
    s_add_u32 s64, s63, 4096
    s_add_u32 s56, s63, 8192
    s_cmp_ge_u32 s26, 2
    s_cselect_b32 s56, 0x7f000000, s56
    s_waitcnt lgkmcnt(0)
    s_barrier
    ds_read_b64_tr_b16 v[36:37], v231 offset:16928
    ds_read_b64_tr_b16 v[38:39], v231 offset:57952
    ds_read_b64_tr_b16 v[40:41], v231 offset:17440
    ds_read_b64_tr_b16 v[42:43], v231 offset:58464
    ds_read_b64_tr_b16 v[44:45], v231 offset:17952
    ds_read_b64_tr_b16 v[46:47], v231 offset:58976
    s_waitcnt lgkmcnt(4)
    buffer_store_dwordx4 v[36:39], v199, s[36:39], s63 offen sc1
    s_waitcnt lgkmcnt(2)
    buffer_store_dwordx4 v[40:43], v199, s[36:39], s64 offen sc1
    s_waitcnt lgkmcnt(0)
    buffer_store_dwordx4 v[44:47], v199, s[36:39], s56 offen sc1
    s_waitcnt vmcnt(0)
    s_cmp_lg_u32 s26, 0
    s_cbranch_scc1 L_ow_9
    s_mov_b32 s56, 262144
    v_mov_b32 v193, 0
L_tag_10:
    buffer_load_dwordx2 v[204:205], v193, s[44:47], 0 offen offset:128 sc1
    s_waitcnt vmcnt(0)
    v_readfirstlane_b32 s28, v204
    v_readfirstlane_b32 s29, v205
    s_sub_u32 s56, s56, 1
    s_cmp_lg_u32 s29, 0
    s_cbranch_scc1 L_tout_11
    s_sleep 4
    s_cmp_lg_u32 s56, 0
    s_cbranch_scc1 L_tag_10
L_tout_11:
    ds_write_b64 v193, v[204:205] offset:14400
    s_waitcnt lgkmcnt(0)
L_ow_9:
    s_barrier
    v_mov_b32 v193, 0
    v_lshlrev_b32 v194, 3, v1
    ds_read_b64 v[204:205], v193 offset:14400
    ds_read_b32 v92, v194 offset:14336
    ds_read_b32 v94, v194 offset:14340
    s_lshl_b32 s52, s27, 7
    s_add_u32 s52, s52, 98304
    s_waitcnt lgkmcnt(0)
    v_readfirstlane_b32 s28, v204
    v_readfirstlane_b32 s29, v205
    s_cmp_lg_u32 s26, 0
    s_cbranch_scc1 L_ns_12
    v_mov_b32 v93, v204
    v_not_b32 v95, v204
    s_mov_b64 exec, 0xff
    buffer_store_dwordx4 v[92:95], v199, s[48:51], s52 offen sc1
    s_mov_b64 exec, -1
L_ns_12:
    s_setprio 1
    s_bfe_u32 s60, s27, 0x20001
    s_lshl_b32 s60, s60, 3
    s_lshr_b32 s52, s27, 5
    s_add_u32 s60, s60, s52
    s_bfe_u32 s61, s27, 0x20003
    s_and_b32 s52, s27, 1
    s_lshl_b32 s52, s52, 2
    s_add_u32 s61, s61, s52
    v_lshrrev_b32 v193, 3, v1
    v_mul_u32_u24 v193, 4096, v193
    v_bfe_u32 v194, v1, 4, 1
    v_lshlrev_b32 v194, 1, v194
    v_and_b32 v195, 7, v1
    v_xor_b32 v194, v194, v195
    v_xor_b32 v195, 0, v194
    v_lshl_add_u32 v232, v195, 4, v193
    v_xor_b32 v195, 4, v194
    v_lshl_add_u32 v233, v195, 4, v193
    v_add_u32 v233, 31744, v233
    v_xor_b32 v195, 0, v194
    v_lshl_add_u32 v234, v195, 4, v193
    v_add_u32 v234, 63488, v234
    v_xor_b32 v195, 4, v194
    v_lshl_add_u32 v235, v195, 4, v193
    v_add_u32 v235, 95232, v235
    v_add_u32 v237, s57, v199
    s_xor_b32 s52, s26, 1
    s_mul_i32 s52, s52, 20480
    v_add_u32 v238, s52, v199
    s_xor_b32 s52, s26, 2
    s_mul_i32 s52, s52, 20480
    v_add_u32 v239, s52, v199
    s_xor_b32 s52, s26, 3
    s_mul_i32 s52, s52, 20480
    v_add_u32 v240, s52, v199
    v_min_u32 v236, 28, v1
    v_lshlrev_b32 v236, 7, v236
    v_lshrrev_b32 v193, 4, v1
    v_and_b32 v194, 15, v1
    v_lshlrev_b32 v195, 15, v193
    v_lshl_add_u32 v244, v194, 3, v195
    v_lshl_add_u32 v243, v194, 4, v195
    v_and_b32 v242, 7, v1
    v_lshlrev_b32 v242, 7, v242
    s_lshl_b32 s69, s26, 19
    s_lshl_b32 s53, s60, 10
    s_add_u32 s69, s69, s53
    s_xor_b32 s52, s26, 0
    s_lshl_b32 s52, s52, 8
    s_add_u32 s65, s52, s69
    s_xor_b32 s52, s26, 1
    s_lshl_b32 s52, s52, 8
    s_add_u32 s66, s52, s69
    s_xor_b32 s52, s26, 2
    s_lshl_b32 s52, s52, 8
    s_add_u32 s67, s52, s69
    s_xor_b32 s52, s26, 3
    s_lshl_b32 s52, s52, 8
    s_add_u32 s68, s52, s69
    s_lshl_b32 s69, s26, 17
    s_lshl_b32 s53, s60, 9
    s_add_u32 s69, s69, s53
    s_add_u32 s69, s69, 2097152
    s_lshl_b32 s70, s60, 12
    s_lshl_b32 s52, s26, 10
    s_add_u32 s70, s70, s52
    s_add_u32 s70, s70, 131072
    s_mov_b32 s44, s18
    s_mov_b32 s45, s19
    s_mov_b32 s46, 0x1000
    s_mov_b32 s47, 0x20000
    v_lshrrev_b32 v193, 4, v1
    v_and_b32 v194, 15, v1
    v_bfe_u32 v195, v1, 2, 2
    v_lshl_add_u32 v195, v193, 3, v195
    v_mul_u32_u24 v231, 160, v195
    v_and_b32 v195, 3, v1
    v_lshl_add_u32 v231, v195, 3, v231
    v_add_u32 v231, s57, v231
    v_mul_u32_u24 v229, 1280, v194
    v_lshrrev_b32 v195, 5, v1
    v_lshl_add_u32 v230, v195, 4, v229
    v_bfe_u32 v195, v1, 4, 1
    v_lshl_add_u32 v229, v195, 5, v230
    v_lshlrev_b32 v196, 1, v194
    v_mov_b32 v228, 0
    s_lshl_b32 s63, s61, 2
    s_add_u32 s63, s63, s26
    s_mul_i32 s63, s63, 25600
    s_mul_i32 s52, s61, 160
    s_lshl_b32 s62, s60, 2
    s_add_u32 s62, s62, s26
    s_lshl_b32 s53, s62, 5
    s_mul_i32 s62, s62, 20480
    s_add_u32 s62, s62, s52
    buffer_load_short_d16_hi v228, v196, s[44:47], s53 offen
    s_add_u32 s40, s24, 0xc80000
    s_addc_u32 s41, s25, 0
    s_mov_b32 s42, 0x21c000
    s_mov_b32 s43, 0x20000
    v_lshlrev_b32 v197, 7, v1
    s_cmp_ge_u32 s27, 216
    s_cbranch_scc1 L_idle_14
    s_mov_b32 s44, s14
    s_mov_b32 s45, s15
    s_mov_b32 s46, 0xd80
    s_mov_b32 s47, 0x20000
    v_lshrrev_b32 v193, 4, v1
    v_lshlrev_b32 v193, 3, v193
    s_lshl_b32 s52, s58, 7
    s_lshl_b32 s53, s26, 5
    s_add_u32 s53, s52, s53
    buffer_load_dwordx2 v[200:201], v193, s[44:47], s53 offen
    v_lshrrev_b32 v194, 3, v1
    v_and_b32 v241, 7, v1
    v_lshlrev_b32 v241, 7, v241
    v_lshl_add_u32 v241, v194, 12, v241
    v_mov_b64 v[4:5], 0
    v_mov_b64 v[6:7], 0
    v_mov_b64 v[8:9], 0
    v_mov_b64 v[10:11], 0
    v_mov_b64 v[12:13], 0
    v_mov_b64 v[14:15], 0
    v_mov_b64 v[16:17], 0
    v_mov_b64 v[18:19], 0
    v_mov_b64 v[20:21], 0
    v_mov_b64 v[22:23], 0
    v_mov_b64 v[24:25], 0
    v_mov_b64 v[26:27], 0
    v_mov_b64 v[28:29], 0
    v_mov_b64 v[30:31], 0
    v_mov_b64 v[32:33], 0
    v_mov_b64 v[34:35], 0
    v_mov_b64 v[36:37], 0
    v_mov_b64 v[38:39], 0
    v_mov_b64 v[40:41], 0
    v_mov_b64 v[42:43], 0
    v_mov_b64 v[44:45], 0
    v_mov_b64 v[46:47], 0
    v_mov_b64 v[48:49], 0
    v_mov_b64 v[50:51], 0
    v_mov_b64 v[52:53], 0
    v_mov_b64 v[54:55], 0
    v_mov_b64 v[56:57], 0
    v_mov_b64 v[58:59], 0
    v_mov_b64 v[60:61], 0
    v_mov_b64 v[62:63], 0
    v_mov_b64 v[64:65], 0
    v_mov_b64 v[66:67], 0
    v_mov_b64 v[68:69], 0
    v_mov_b64 v[70:71], 0
    v_mov_b64 v[72:73], 0
    v_mov_b64 v[74:75], 0
    v_mov_b64 v[76:77], 0
    v_mov_b64 v[78:79], 0
    v_mov_b64 v[80:81], 0
    v_mov_b64 v[82:83], 0
    s_waitcnt vmcnt(0)
    v_lshlrev_b32 v4, 16, v200
    v_and_b32 v5, 0xffff0000, v200
    v_lshlrev_b32 v6, 16, v201
    v_and_b32 v7, 0xffff0000, v201
    v_lshlrev_b32 v8, 16, v200
    v_and_b32 v9, 0xffff0000, v200
    v_lshlrev_b32 v10, 16, v201
    v_and_b32 v11, 0xffff0000, v201
    v_lshlrev_b32 v12, 16, v200
    v_and_b32 v13, 0xffff0000, v200
    v_lshlrev_b32 v14, 16, v201
    v_and_b32 v15, 0xffff0000, v201
    v_lshlrev_b32 v16, 16, v200
    v_and_b32 v17, 0xffff0000, v200
    v_lshlrev_b32 v18, 16, v201
    v_and_b32 v19, 0xffff0000, v201
    v_lshlrev_b32 v20, 16, v200
    v_and_b32 v21, 0xffff0000, v200
    v_lshlrev_b32 v22, 16, v201
    v_and_b32 v23, 0xffff0000, v201
    s_cmp_lg_u32 s26, 0
    s_cbranch_scc1 L_ow_15
    s_lshl_b32 s52, s27, 7
    s_add_u32 s52, s52, 65536
    v_mov_b32 v198, 0
    s_mov_b32 s56, 262144
L_poll_16:
    buffer_load_dwordx2 v[204:205], v198, s[48:51], s52 offen offset:0 sc1
    s_waitcnt vmcnt(0)
    v_cmpx_eq_u64 vcc, s[28:29], v[204:205]
    s_sub_u32 s56, s56, 1
    s_cmp_eq_u64 vcc, -1
    s_mov_b64 exec, -1
    s_cbranch_scc1 L_pout_17
    s_sleep 8
    s_cmp_lg_u32 s56, 0
    s_cbranch_scc1 L_poll_16
L_pout_17:
L_ow_15:
    s_barrier
    s_add_u32 m0, s57, 0
    s_nop 0
    buffer_load_dwordx4 v188, s[32:35], s54 offen offset:0 lds
    buffer_load_dwordx4 v189, s[32:35], s54 offen offset:1024 lds
    buffer_load_dwordx4 v190, s[32:35], s54 offen offset:2048 lds
    buffer_load_dwordx4 v191, s[32:35], s54 offen offset:3072 lds
    buffer_load_dwordx4 v[104:107], v192, s[36:39], s55 offen offset:0 sc1
    buffer_load_dwordx4 v[108:111], v192, s[36:39], s55 offen offset:256 sc1
    buffer_load_dwordx4 v[112:115], v192, s[36:39], s55 offen offset:512 sc1
    buffer_load_dwordx4 v[116:119], v192, s[36:39], s55 offen offset:768 sc1
    buffer_load_dwordx4 v[120:123], v192, s[36:39], s55 offen offset:1024 sc1
    s_add_u32 s54, s54, 442368
    s_add_u32 s55, s55, 163840
    s_add_u32 m0, s57, 5120
    s_nop 0
    buffer_load_dwordx4 v188, s[32:35], s54 offen offset:0 lds
    buffer_load_dwordx4 v189, s[32:35], s54 offen offset:1024 lds
    buffer_load_dwordx4 v190, s[32:35], s54 offen offset:2048 lds
    buffer_load_dwordx4 v191, s[32:35], s54 offen offset:3072 lds
    buffer_load_dwordx4 v[124:127], v192, s[36:39], s55 offen offset:0 sc1
    buffer_load_dwordx4 v[128:131], v192, s[36:39], s55 offen offset:256 sc1
    buffer_load_dwordx4 v[132:135], v192, s[36:39], s55 offen offset:512 sc1
    buffer_load_dwordx4 v[136:139], v192, s[36:39], s55 offen offset:768 sc1
    buffer_load_dwordx4 v[140:143], v192, s[36:39], s55 offen offset:1024 sc1
    s_add_u32 s54, s54, 442368
    s_add_u32 s55, s55, 163840
    s_add_u32 m0, s57, 10240
    s_nop 0
    buffer_load_dwordx4 v188, s[32:35], s54 offen offset:0 lds
    buffer_load_dwordx4 v189, s[32:35], s54 offen offset:1024 lds
    buffer_load_dwordx4 v190, s[32:35], s54 offen offset:2048 lds
    buffer_load_dwordx4 v191, s[32:35], s54 offen offset:3072 lds
    buffer_load_dwordx4 v[144:147], v192, s[36:39], s55 offen offset:0 sc1
    buffer_load_dwordx4 v[148:151], v192, s[36:39], s55 offen offset:256 sc1
    buffer_load_dwordx4 v[152:155], v192, s[36:39], s55 offen offset:512 sc1
    buffer_load_dwordx4 v[156:159], v192, s[36:39], s55 offen offset:768 sc1
    buffer_load_dwordx4 v[160:163], v192, s[36:39], s55 offen offset:1024 sc1
    s_add_u32 s54, s54, 442368
    s_add_u32 s55, s55, 163840
    s_waitcnt vmcnt(23)
    ds_read_b64_tr_b16 v[84:85], v184 offset:0
    ds_read_b64_tr_b16 v[86:87], v184 offset:512
    ds_read_b64_tr_b16 v[88:89], v185 offset:0
    ds_read_b64_tr_b16 v[90:91], v185 offset:512
    ds_read_b64_tr_b16 v[92:93], v186 offset:0
    ds_read_b64_tr_b16 v[94:95], v186 offset:512
    ds_read_b64_tr_b16 v[96:97], v187 offset:0
    ds_read_b64_tr_b16 v[98:99], v187 offset:512
    s_mov_b32 s56, 16
.p2align 6
L_gl_18:
    s_waitcnt vmcnt(18)
    s_waitcnt lgkmcnt(6)
    v_mfma_f32_16x16x32_bf16 v[4:7], v[84:87], v[104:107], v[4:7]
    v_mfma_f32_16x16x32_bf16 v[8:11], v[84:87], v[108:111], v[8:11]
    s_add_u32 m0, s57, 15360
    s_nop 0
    buffer_load_dwordx4 v188, s[32:35], s54 offen offset:0 lds
    v_mfma_f32_16x16x32_bf16 v[12:15], v[84:87], v[112:115], v[12:15]
    v_mfma_f32_16x16x32_bf16 v[16:19], v[84:87], v[116:119], v[16:19]
    buffer_load_dwordx4 v189, s[32:35], s54 offen offset:1024 lds
    v_mfma_f32_16x16x32_bf16 v[20:23], v[84:87], v[120:123], v[20:23]
    s_waitcnt vmcnt(16)
    ds_read_b64_tr_b16 v[84:85], v184 offset:5120
    ds_read_b64_tr_b16 v[86:87], v184 offset:5632
    s_waitcnt lgkmcnt(6)
    v_mfma_f32_16x16x32_bf16 v[24:27], v[88:91], v[104:107], v[24:27]
    buffer_load_dwordx4 v190, s[32:35], s54 offen offset:2048 lds
    v_mfma_f32_16x16x32_bf16 v[28:31], v[88:91], v[108:111], v[28:31]
    buffer_load_dwordx4 v191, s[32:35], s54 offen offset:3072 lds
    v_mfma_f32_16x16x32_bf16 v[32:35], v[88:91], v[112:115], v[32:35]
    v_mfma_f32_16x16x32_bf16 v[36:39], v[88:91], v[116:119], v[36:39]
    s_add_u32 s54, s54, 442368
    buffer_load_dwordx4 v[164:167], v192, s[36:39], s55 offen offset:0 sc1
    v_mfma_f32_16x16x32_bf16 v[40:43], v[88:91], v[120:123], v[40:43]
    ds_read_b64_tr_b16 v[88:89], v185 offset:5120
    ds_read_b64_tr_b16 v[90:91], v185 offset:5632
    s_waitcnt lgkmcnt(6)
    v_mfma_f32_16x16x32_bf16 v[44:47], v[92:95], v[104:107], v[44:47]
    buffer_load_dwordx4 v[168:171], v192, s[36:39], s55 offen offset:256 sc1
    v_mfma_f32_16x16x32_bf16 v[48:51], v[92:95], v[108:111], v[48:51]
    buffer_load_dwordx4 v[172:175], v192, s[36:39], s55 offen offset:512 sc1
    v_mfma_f32_16x16x32_bf16 v[52:55], v[92:95], v[112:115], v[52:55]
    v_mfma_f32_16x16x32_bf16 v[56:59], v[92:95], v[116:119], v[56:59]
    buffer_load_dwordx4 v[176:179], v192, s[36:39], s55 offen offset:768 sc1
    v_mfma_f32_16x16x32_bf16 v[60:63], v[92:95], v[120:123], v[60:63]
    ds_read_b64_tr_b16 v[92:93], v186 offset:5120
    ds_read_b64_tr_b16 v[94:95], v186 offset:5632
    s_waitcnt lgkmcnt(6)
    v_mfma_f32_16x16x32_bf16 v[64:67], v[96:99], v[104:107], v[64:67]
    buffer_load_dwordx4 v[180:183], v192, s[36:39], s55 offen offset:1024 sc1
    v_mfma_f32_16x16x32_bf16 v[68:71], v[96:99], v[108:111], v[68:71]
    s_add_u32 s55, s55, 163840
    v_mfma_f32_16x16x32_bf16 v[72:75], v[96:99], v[112:115], v[72:75]
    v_mfma_f32_16x16x32_bf16 v[76:79], v[96:99], v[116:119], v[76:79]
    v_mfma_f32_16x16x32_bf16 v[80:83], v[96:99], v[120:123], v[80:83]
    ds_read_b64_tr_b16 v[96:97], v187 offset:5120
    ds_read_b64_tr_b16 v[98:99], v187 offset:5632
    s_waitcnt vmcnt(18)
    s_waitcnt lgkmcnt(6)
    v_mfma_f32_16x16x32_bf16 v[4:7], v[84:87], v[124:127], v[4:7]
    v_mfma_f32_16x16x32_bf16 v[8:11], v[84:87], v[128:131], v[8:11]
    s_add_u32 m0, s57, 0
    s_nop 0
    buffer_load_dwordx4 v188, s[32:35], s54 offen offset:0 lds
    v_mfma_f32_16x16x32_bf16 v[12:15], v[84:87], v[132:135], v[12:15]
    v_mfma_f32_16x16x32_bf16 v[16:19], v[84:87], v[136:139], v[16:19]
    buffer_load_dwordx4 v189, s[32:35], s54 offen offset:1024 lds
    v_mfma_f32_16x16x32_bf16 v[20:23], v[84:87], v[140:143], v[20:23]
    s_waitcnt vmcnt(16)
    ds_read_b64_tr_b16 v[84:85], v184 offset:10240
    ds_read_b64_tr_b16 v[86:87], v184 offset:10752
    s_waitcnt lgkmcnt(6)
    v_mfma_f32_16x16x32_bf16 v[24:27], v[88:91], v[124:127], v[24:27]
    buffer_load_dwordx4 v190, s[32:35], s54 offen offset:2048 lds
    v_mfma_f32_16x16x32_bf16 v[28:31], v[88:91], v[128:131], v[28:31]
    buffer_load_dwordx4 v191, s[32:35], s54 offen offset:3072 lds
    v_mfma_f32_16x16x32_bf16 v[32:35], v[88:91], v[132:135], v[32:35]
    v_mfma_f32_16x16x32_bf16 v[36:39], v[88:91], v[136:139], v[36:39]
    s_add_u32 s54, s54, 442368
    buffer_load_dwordx4 v[104:107], v192, s[36:39], s55 offen offset:0 sc1
    v_mfma_f32_16x16x32_bf16 v[40:43], v[88:91], v[140:143], v[40:43]
    ds_read_b64_tr_b16 v[88:89], v185 offset:10240
    ds_read_b64_tr_b16 v[90:91], v185 offset:10752
    s_waitcnt lgkmcnt(6)
    v_mfma_f32_16x16x32_bf16 v[44:47], v[92:95], v[124:127], v[44:47]
    buffer_load_dwordx4 v[108:111], v192, s[36:39], s55 offen offset:256 sc1
    v_mfma_f32_16x16x32_bf16 v[48:51], v[92:95], v[128:131], v[48:51]
    buffer_load_dwordx4 v[112:115], v192, s[36:39], s55 offen offset:512 sc1
    v_mfma_f32_16x16x32_bf16 v[52:55], v[92:95], v[132:135], v[52:55]
    v_mfma_f32_16x16x32_bf16 v[56:59], v[92:95], v[136:139], v[56:59]
    buffer_load_dwordx4 v[116:119], v192, s[36:39], s55 offen offset:768 sc1
    v_mfma_f32_16x16x32_bf16 v[60:63], v[92:95], v[140:143], v[60:63]
    ds_read_b64_tr_b16 v[92:93], v186 offset:10240
    ds_read_b64_tr_b16 v[94:95], v186 offset:10752
    s_waitcnt lgkmcnt(6)
    v_mfma_f32_16x16x32_bf16 v[64:67], v[96:99], v[124:127], v[64:67]
    buffer_load_dwordx4 v[120:123], v192, s[36:39], s55 offen offset:1024 sc1
    v_mfma_f32_16x16x32_bf16 v[68:71], v[96:99], v[128:131], v[68:71]
    s_add_u32 s55, s55, 163840
    v_mfma_f32_16x16x32_bf16 v[72:75], v[96:99], v[132:135], v[72:75]
    v_mfma_f32_16x16x32_bf16 v[76:79], v[96:99], v[136:139], v[76:79]
    v_mfma_f32_16x16x32_bf16 v[80:83], v[96:99], v[140:143], v[80:83]
    ds_read_b64_tr_b16 v[96:97], v187 offset:10240
    ds_read_b64_tr_b16 v[98:99], v187 offset:10752
    s_waitcnt vmcnt(18)
    s_waitcnt lgkmcnt(6)
    v_mfma_f32_16x16x32_bf16 v[4:7], v[84:87], v[144:147], v[4:7]
    v_mfma_f32_16x16x32_bf16 v[8:11], v[84:87], v[148:151], v[8:11]
    s_add_u32 m0, s57, 5120
    s_nop 0
    buffer_load_dwordx4 v188, s[32:35], s54 offen offset:0 lds
    v_mfma_f32_16x16x32_bf16 v[12:15], v[84:87], v[152:155], v[12:15]
    v_mfma_f32_16x16x32_bf16 v[16:19], v[84:87], v[156:159], v[16:19]
    buffer_load_dwordx4 v189, s[32:35], s54 offen offset:1024 lds
    v_mfma_f32_16x16x32_bf16 v[20:23], v[84:87], v[160:163], v[20:23]
    s_waitcnt vmcnt(16)
    ds_read_b64_tr_b16 v[84:85], v184 offset:15360
    ds_read_b64_tr_b16 v[86:87], v184 offset:15872
    s_waitcnt lgkmcnt(6)
    v_mfma_f32_16x16x32_bf16 v[24:27], v[88:91], v[144:147], v[24:27]
    buffer_load_dwordx4 v190, s[32:35], s54 offen offset:2048 lds
    v_mfma_f32_16x16x32_bf16 v[28:31], v[88:91], v[148:151], v[28:31]
    buffer_load_dwordx4 v191, s[32:35], s54 offen offset:3072 lds
    v_mfma_f32_16x16x32_bf16 v[32:35], v[88:91], v[152:155], v[32:35]
    v_mfma_f32_16x16x32_bf16 v[36:39], v[88:91], v[156:159], v[36:39]
    s_add_u32 s54, s54, 442368
    buffer_load_dwordx4 v[124:127], v192, s[36:39], s55 offen offset:0 sc1
    v_mfma_f32_16x16x32_bf16 v[40:43], v[88:91], v[160:163], v[40:43]
    ds_read_b64_tr_b16 v[88:89], v185 offset:15360
    ds_read_b64_tr_b16 v[90:91], v185 offset:15872
    s_waitcnt lgkmcnt(6)
    v_mfma_f32_16x16x32_bf16 v[44:47], v[92:95], v[144:147], v[44:47]
    buffer_load_dwordx4 v[128:131], v192, s[36:39], s55 offen offset:256 sc1
    v_mfma_f32_16x16x32_bf16 v[48:51], v[92:95], v[148:151], v[48:51]
    buffer_load_dwordx4 v[132:135], v192, s[36:39], s55 offen offset:512 sc1
    v_mfma_f32_16x16x32_bf16 v[52:55], v[92:95], v[152:155], v[52:55]
    v_mfma_f32_16x16x32_bf16 v[56:59], v[92:95], v[156:159], v[56:59]
    buffer_load_dwordx4 v[136:139], v192, s[36:39], s55 offen offset:768 sc1
    v_mfma_f32_16x16x32_bf16 v[60:63], v[92:95], v[160:163], v[60:63]
    ds_read_b64_tr_b16 v[92:93], v186 offset:15360
    ds_read_b64_tr_b16 v[94:95], v186 offset:15872
    s_waitcnt lgkmcnt(6)
    v_mfma_f32_16x16x32_bf16 v[64:67], v[96:99], v[144:147], v[64:67]
    buffer_load_dwordx4 v[140:143], v192, s[36:39], s55 offen offset:1024 sc1
    v_mfma_f32_16x16x32_bf16 v[68:71], v[96:99], v[148:151], v[68:71]
    s_add_u32 s55, s55, 163840
    v_mfma_f32_16x16x32_bf16 v[72:75], v[96:99], v[152:155], v[72:75]
    v_mfma_f32_16x16x32_bf16 v[76:79], v[96:99], v[156:159], v[76:79]
    v_mfma_f32_16x16x32_bf16 v[80:83], v[96:99], v[160:163], v[80:83]
    ds_read_b64_tr_b16 v[96:97], v187 offset:15360
    ds_read_b64_tr_b16 v[98:99], v187 offset:15872
    s_waitcnt vmcnt(18)
    s_waitcnt lgkmcnt(6)
    v_mfma_f32_16x16x32_bf16 v[4:7], v[84:87], v[164:167], v[4:7]
    v_mfma_f32_16x16x32_bf16 v[8:11], v[84:87], v[168:171], v[8:11]
    s_add_u32 m0, s57, 10240
    s_nop 0
    buffer_load_dwordx4 v188, s[32:35], s54 offen offset:0 lds
    v_mfma_f32_16x16x32_bf16 v[12:15], v[84:87], v[172:175], v[12:15]
    v_mfma_f32_16x16x32_bf16 v[16:19], v[84:87], v[176:179], v[16:19]
    buffer_load_dwordx4 v189, s[32:35], s54 offen offset:1024 lds
    v_mfma_f32_16x16x32_bf16 v[20:23], v[84:87], v[180:183], v[20:23]
    s_waitcnt vmcnt(16)
    ds_read_b64_tr_b16 v[84:85], v184 offset:0
    ds_read_b64_tr_b16 v[86:87], v184 offset:512
    s_waitcnt lgkmcnt(6)
    v_mfma_f32_16x16x32_bf16 v[24:27], v[88:91], v[164:167], v[24:27]
    buffer_load_dwordx4 v190, s[32:35], s54 offen offset:2048 lds
    v_mfma_f32_16x16x32_bf16 v[28:31], v[88:91], v[168:171], v[28:31]
    buffer_load_dwordx4 v191, s[32:35], s54 offen offset:3072 lds
    v_mfma_f32_16x16x32_bf16 v[32:35], v[88:91], v[172:175], v[32:35]
    v_mfma_f32_16x16x32_bf16 v[36:39], v[88:91], v[176:179], v[36:39]
    s_add_u32 s54, s54, 442368
    buffer_load_dwordx4 v[144:147], v192, s[36:39], s55 offen offset:0 sc1
    v_mfma_f32_16x16x32_bf16 v[40:43], v[88:91], v[180:183], v[40:43]
    ds_read_b64_tr_b16 v[88:89], v185 offset:0
    ds_read_b64_tr_b16 v[90:91], v185 offset:512
    s_waitcnt lgkmcnt(6)
    v_mfma_f32_16x16x32_bf16 v[44:47], v[92:95], v[164:167], v[44:47]
    buffer_load_dwordx4 v[148:151], v192, s[36:39], s55 offen offset:256 sc1
    v_mfma_f32_16x16x32_bf16 v[48:51], v[92:95], v[168:171], v[48:51]
    buffer_load_dwordx4 v[152:155], v192, s[36:39], s55 offen offset:512 sc1
    v_mfma_f32_16x16x32_bf16 v[52:55], v[92:95], v[172:175], v[52:55]
    v_mfma_f32_16x16x32_bf16 v[56:59], v[92:95], v[176:179], v[56:59]
    buffer_load_dwordx4 v[156:159], v192, s[36:39], s55 offen offset:768 sc1
    v_mfma_f32_16x16x32_bf16 v[60:63], v[92:95], v[180:183], v[60:63]
    ds_read_b64_tr_b16 v[92:93], v186 offset:0
    ds_read_b64_tr_b16 v[94:95], v186 offset:512
    s_waitcnt lgkmcnt(6)
    v_mfma_f32_16x16x32_bf16 v[64:67], v[96:99], v[164:167], v[64:67]
    buffer_load_dwordx4 v[160:163], v192, s[36:39], s55 offen offset:1024 sc1
    v_mfma_f32_16x16x32_bf16 v[68:71], v[96:99], v[168:171], v[68:71]
    s_add_u32 s55, s55, 163840
    v_mfma_f32_16x16x32_bf16 v[72:75], v[96:99], v[172:175], v[72:75]
    v_mfma_f32_16x16x32_bf16 v[76:79], v[96:99], v[176:179], v[76:79]
    v_mfma_f32_16x16x32_bf16 v[80:83], v[96:99], v[180:183], v[80:83]
    ds_read_b64_tr_b16 v[96:97], v187 offset:0
    ds_read_b64_tr_b16 v[98:99], v187 offset:512
    s_sub_u32 s56, s56, 4
    s_cmp_eq_u32 s56, 0
    s_cbranch_scc0 L_gl_18
L_gd_19:
    s_setprio 3
    s_waitcnt vmcnt(0)
    ds_write_b128 v237, v[24:27] offset:0
    ds_write_b128 v237, v[28:31] offset:1024
    ds_write_b128 v237, v[32:35] offset:2048
    ds_write_b128 v237, v[36:39] offset:3072
    ds_write_b128 v237, v[40:43] offset:4096
    ds_write_b128 v237, v[44:47] offset:5120
    ds_write_b128 v237, v[48:51] offset:6144
    ds_write_b128 v237, v[52:55] offset:7168
    ds_write_b128 v237, v[56:59] offset:8192
    ds_write_b128 v237, v[60:63] offset:9216
    ds_write_b128 v237, v[64:67] offset:10240
    ds_write_b128 v237, v[68:71] offset:11264
    ds_write_b128 v237, v[72:75] offset:12288
    ds_write_b128 v237, v[76:79] offset:13312
    ds_write_b128 v237, v[80:83] offset:14336
    s_waitcnt lgkmcnt(0)
    s_barrier
    ds_read_b128 v[24:27], v238 offset:0
    ds_read_b128 v[44:47], v239 offset:5120
    ds_read_b128 v[64:67], v240 offset:10240
    ds_read_b128 v[28:31], v238 offset:1024
    ds_read_b128 v[48:51], v239 offset:6144
    ds_read_b128 v[68:71], v240 offset:11264
    ds_read_b128 v[32:35], v238 offset:2048
    ds_read_b128 v[52:55], v239 offset:7168
    ds_read_b128 v[72:75], v240 offset:12288
    ds_read_b128 v[36:39], v238 offset:3072
    ds_read_b128 v[56:59], v239 offset:8192
    ds_read_b128 v[76:79], v240 offset:13312
    ds_read_b128 v[40:43], v238 offset:4096
    ds_read_b128 v[60:63], v239 offset:9216
    ds_read_b128 v[80:83], v240 offset:14336
    s_waitcnt lgkmcnt(12)
    v_add_f32 v4, v4, v24
    v_add_f32 v5, v5, v25
    v_add_f32 v6, v6, v26
    v_add_f32 v7, v7, v27
    v_add_f32 v4, v4, v44
    v_add_f32 v5, v5, v45
    v_add_f32 v6, v6, v46
    v_add_f32 v7, v7, v47
    v_add_f32 v4, v4, v64
    v_add_f32 v5, v5, v65
    v_add_f32 v6, v6, v66
    v_add_f32 v7, v7, v67
    s_waitcnt lgkmcnt(9)
    v_add_f32 v8, v8, v28
    v_add_f32 v9, v9, v29
    v_add_f32 v10, v10, v30
    v_add_f32 v11, v11, v31
    v_add_f32 v8, v8, v48
    v_add_f32 v9, v9, v49
    v_add_f32 v10, v10, v50
    v_add_f32 v11, v11, v51
    v_add_f32 v8, v8, v68
    v_add_f32 v9, v9, v69
    v_add_f32 v10, v10, v70
    v_add_f32 v11, v11, v71
    s_waitcnt lgkmcnt(6)
    v_add_f32 v12, v12, v32
    v_add_f32 v13, v13, v33
    v_add_f32 v14, v14, v34
    v_add_f32 v15, v15, v35
    v_add_f32 v12, v12, v52
    v_add_f32 v13, v13, v53
    v_add_f32 v14, v14, v54
    v_add_f32 v15, v15, v55
    v_add_f32 v12, v12, v72
    v_add_f32 v13, v13, v73
    v_add_f32 v14, v14, v74
    v_add_f32 v15, v15, v75
    s_waitcnt lgkmcnt(3)
    v_add_f32 v16, v16, v36
    v_add_f32 v17, v17, v37
    v_add_f32 v18, v18, v38
    v_add_f32 v19, v19, v39
    v_add_f32 v16, v16, v56
    v_add_f32 v17, v17, v57
    v_add_f32 v18, v18, v58
    v_add_f32 v19, v19, v59
    v_add_f32 v16, v16, v76
    v_add_f32 v17, v17, v77
    v_add_f32 v18, v18, v78
    v_add_f32 v19, v19, v79
    s_waitcnt lgkmcnt(0)
    v_add_f32 v20, v20, v40
    v_add_f32 v21, v21, v41
    v_add_f32 v22, v22, v42
    v_add_f32 v23, v23, v43
    v_add_f32 v20, v20, v60
    v_add_f32 v21, v21, v61
    v_add_f32 v22, v22, v62
    v_add_f32 v23, v23, v63
    v_add_f32 v20, v20, v80
    v_add_f32 v21, v21, v81
    v_add_f32 v22, v22, v82
    v_add_f32 v23, v23, v83
    v_mov_b32 v197, 0xc0135761
    s_mov_b32 s52, 0xbdd2d3e8
    v_mul_f32 v24, v4, v4
    v_mul_f32 v25, v5, v5
    v_mul_f32 v26, v6, v6
    v_mul_f32 v27, v7, v7
    v_fma_f32 v24, v24, s52, v197
    v_fma_f32 v25, v25, s52, v197
    v_fma_f32 v26, v26, s52, v197
    v_fma_f32 v27, v27, s52, v197
    v_mul_f32 v24, v24, v4
    v_mul_f32 v25, v25, v5
    v_mul_f32 v26, v26, v6
    v_mul_f32 v27, v27, v7
    v_exp_f32 v24, v24
    v_exp_f32 v25, v25
    v_exp_f32 v26, v26
    v_exp_f32 v27, v27
    v_add_f32 v24, 1.0, v24
    v_add_f32 v25, 1.0, v25
    v_add_f32 v26, 1.0, v26
    v_add_f32 v27, 1.0, v27
    v_rcp_f32 v24, v24
    v_rcp_f32 v25, v25
    v_rcp_f32 v26, v26
    v_rcp_f32 v27, v27
    v_mul_f32 v4, v4, v24
    v_mul_f32 v5, v5, v25
    v_mul_f32 v6, v6, v26
    v_mul_f32 v7, v7, v27
    v_mul_f32 v28, v8, v8
    v_mul_f32 v29, v9, v9
    v_mul_f32 v30, v10, v10
    v_mul_f32 v31, v11, v11
    v_fma_f32 v28, v28, s52, v197
    v_fma_f32 v29, v29, s52, v197
    v_fma_f32 v30, v30, s52, v197
    v_fma_f32 v31, v31, s52, v197
    v_mul_f32 v28, v28, v8
    v_mul_f32 v29, v29, v9
    v_mul_f32 v30, v30, v10
    v_mul_f32 v31, v31, v11
    v_exp_f32 v28, v28
    v_exp_f32 v29, v29
    v_exp_f32 v30, v30
    v_exp_f32 v31, v31
    v_add_f32 v28, 1.0, v28
    v_add_f32 v29, 1.0, v29
    v_add_f32 v30, 1.0, v30
    v_add_f32 v31, 1.0, v31
    v_rcp_f32 v28, v28
    v_rcp_f32 v29, v29
    v_rcp_f32 v30, v30
    v_rcp_f32 v31, v31
    v_mul_f32 v8, v8, v28
    v_mul_f32 v9, v9, v29
    v_mul_f32 v10, v10, v30
    v_mul_f32 v11, v11, v31
    v_mul_f32 v32, v12, v12
    v_mul_f32 v33, v13, v13
    v_mul_f32 v34, v14, v14
    v_mul_f32 v35, v15, v15
    v_fma_f32 v32, v32, s52, v197
    v_fma_f32 v33, v33, s52, v197
    v_fma_f32 v34, v34, s52, v197
    v_fma_f32 v35, v35, s52, v197
    v_mul_f32 v32, v32, v12
    v_mul_f32 v33, v33, v13
    v_mul_f32 v34, v34, v14
    v_mul_f32 v35, v35, v15
    v_exp_f32 v32, v32
    v_exp_f32 v33, v33
    v_exp_f32 v34, v34
    v_exp_f32 v35, v35
    v_add_f32 v32, 1.0, v32
    v_add_f32 v33, 1.0, v33
    v_add_f32 v34, 1.0, v34
    v_add_f32 v35, 1.0, v35
    v_rcp_f32 v32, v32
    v_rcp_f32 v33, v33
    v_rcp_f32 v34, v34
    v_rcp_f32 v35, v35
    v_mul_f32 v12, v12, v32
    v_mul_f32 v13, v13, v33
    v_mul_f32 v14, v14, v34
    v_mul_f32 v15, v15, v35
    v_mul_f32 v36, v16, v16
    v_mul_f32 v37, v17, v17
    v_mul_f32 v38, v18, v18
    v_mul_f32 v39, v19, v19
    v_fma_f32 v36, v36, s52, v197
    v_fma_f32 v37, v37, s52, v197
    v_fma_f32 v38, v38, s52, v197
    v_fma_f32 v39, v39, s52, v197
    v_mul_f32 v36, v36, v16
    v_mul_f32 v37, v37, v17
    v_mul_f32 v38, v38, v18
    v_mul_f32 v39, v39, v19
    v_exp_f32 v36, v36
    v_exp_f32 v37, v37
    v_exp_f32 v38, v38
    v_exp_f32 v39, v39
    v_add_f32 v36, 1.0, v36
    v_add_f32 v37, 1.0, v37
    v_add_f32 v38, 1.0, v38
    v_add_f32 v39, 1.0, v39
    v_rcp_f32 v36, v36
    v_rcp_f32 v37, v37
    v_rcp_f32 v38, v38
    v_rcp_f32 v39, v39
    v_mul_f32 v16, v16, v36
    v_mul_f32 v17, v17, v37
    v_mul_f32 v18, v18, v38
    v_mul_f32 v19, v19, v39
    v_mul_f32 v40, v20, v20
    v_mul_f32 v41, v21, v21
    v_mul_f32 v42, v22, v22
    v_mul_f32 v43, v23, v23
    v_fma_f32 v40, v40, s52, v197
    v_fma_f32 v41, v41, s52, v197
    v_fma_f32 v42, v42, s52, v197
    v_fma_f32 v43, v43, s52, v197
    v_mul_f32 v40, v40, v20
    v_mul_f32 v41, v41, v21
    v_mul_f32 v42, v42, v22
    v_mul_f32 v43, v43, v23
    v_exp_f32 v40, v40
    v_exp_f32 v41, v41
    v_exp_f32 v42, v42
    v_exp_f32 v43, v43
    v_add_f32 v40, 1.0, v40
    v_add_f32 v41, 1.0, v41
    v_add_f32 v42, 1.0, v42
    v_add_f32 v43, 1.0, v43
    v_rcp_f32 v40, v40
    v_rcp_f32 v41, v41
    v_rcp_f32 v42, v42
    v_rcp_f32 v43, v43
    v_mul_f32 v20, v20, v40
    v_mul_f32 v21, v21, v41
    v_mul_f32 v22, v22, v42
    v_mul_f32 v23, v23, v43
    v_lshrrev_b32 v193, 5, v1
    v_mul_u32_u24 v193, 10240, v193
    v_and_b32 v194, 31, v1
    v_lshl_add_u32 v194, v194, 4, v193
    s_lshl_b32 s52, s58, 2
    s_add_u32 s52, s52, s26
    s_mul_i32 s52, s52, 20480
    s_mul_i32 s53, s59, 1280
    s_add_u32 s52, s52, s53
    v_cvt_pk_bf16_f32 v204, v4, v5
    v_cvt_pk_bf16_f32 v205, v6, v7
    v_cvt_pk_bf16_f32 v206, v8, v9
    v_cvt_pk_bf16_f32 v207, v10, v11
    v_cvt_pk_bf16_f32 v208, v12, v13
    v_cvt_pk_bf16_f32 v209, v14, v15
    v_cvt_pk_bf16_f32 v210, v16, v17
    v_cvt_pk_bf16_f32 v211, v18, v19
    v_cvt_pk_bf16_f32 v212, v20, v21
    v_cvt_pk_bf16_f32 v213, v22, v23
    v_mov_b32 v214, v212
    v_mov_b32 v215, v213
    v_permlane16_swap_b32 v204, v206
    v_permlane16_swap_b32 v205, v207
    v_permlane16_swap_b32 v208, v210
    v_permlane16_swap_b32 v209, v211
    v_permlane16_swap_b32 v212, v214
    v_permlane16_swap_b32 v213, v215
    buffer_store_dwordx4 v[204:207], v194, s[40:43], s52 offen sc1
    buffer_store_dwordx4 v[208:211], v194, s[40:43], s52 offen offset:512 sc1
    s_mov_b32 exec_lo, 0xffff
    s_mov_b32 exec_hi, 0xffff
    buffer_store_dwordx4 v[212:215], v194, s[40:43], s52 offen offset:1024 sc1
    s_mov_b64 exec, -1
    s_lshl_b32 s52, s59, 5
    s_add_u32 s52, s52, s58
    s_lshl_b32 s52, s52, 7
    s_waitcnt vmcnt(0)
    s_barrier
    s_cmp_lg_u32 s26, 0
    s_cbranch_scc1 L_second_13
    v_mov_b32 v193, 0
    v_mov_b32 v204, s28
    v_mov_b32 v205, s29
    s_mov_b64 exec, 1
    buffer_store_dwordx2 v[204:205], v193, s[48:51], s52 offen sc1
    s_mov_b64 exec, -1
    s_branch L_second_13
L_idle_14:
    s_cmp_lt_u32 s27, 240
    s_cbranch_scc1 L_grp_20
    s_mov_b32 s32, s12
    s_mov_b32 s33, s13
    s_mov_b32 s34, 0x6c0000
    s_mov_b32 s35, 0x20000
    s_sub_u32 s52, s27, 240
    s_lshl_b32 s52, s52, 2
    s_add_u32 s52, s52, s26
    s_lshl_b32 s54, s52, 13
    s_mov_b32 s56, 14
L_pf_22:
    buffer_load_dword v198, v197, s[32:35], s54 offen
    s_add_u32 s54, s54, 524288
    s_sub_u32 s56, s56, 1
    s_cmp_lg_u32 s56, 0
    s_waitcnt vmcnt(0)
    s_cbranch_scc1 L_pf_22
    s_branch L_both_21
L_grp_20:
    s_cmp_lg_u32 s26, 0
    s_cbranch_scc1 L_ow_23
    s_lshl_b32 s52, s27, 7
    s_add_u32 s52, s52, 65536
    v_mov_b32 v198, 0
    s_mov_b32 s56, 262144
L_poll_24:
    buffer_load_dwordx2 v[204:205], v198, s[48:51], s52 offen offset:0 sc1
    s_waitcnt vmcnt(0)
    v_cmpx_eq_u64 vcc, s[28:29], v[204:205]
    s_sub_u32 s56, s56, 1
    s_cmp_eq_u64 vcc, -1
    s_mov_b64 exec, -1
    s_cbranch_scc1 L_pout_25
    s_sleep 8
    s_cmp_lg_u32 s56, 0
    s_cbranch_scc1 L_poll_24
L_pout_25:
L_ow_23:
    s_barrier
    s_cmp_ge_u32 s27, 232
    s_cbranch_scc1 L_wf_26
    v_add_u32 v24, 0, v1
    v_mul_u32_u24 v25, 6554, v24
    v_lshrrev_b32 v25, 16, v25
    v_mul_u32_u24 v26, 1120, v25
    v_lshl_add_u32 v24, v24, 4, v26
    v_lshrrev_b32 v26, 4, v25
    v_mul_u32_u24 v26, 10240, v26
    v_add_u32 v4, v24, v26
    v_lshrrev_b32 v26, 3, v25
    v_mul_u32_u24 v26, 40960, v26
    v_add_u32 v12, v24, v26
    v_add_u32 v24, 64, v1
    v_mul_u32_u24 v25, 6554, v24
    v_lshrrev_b32 v25, 16, v25
    v_mul_u32_u24 v26, 1120, v25
    v_lshl_add_u32 v24, v24, 4, v26
    v_lshrrev_b32 v26, 4, v25
    v_mul_u32_u24 v26, 10240, v26
    v_add_u32 v5, v24, v26
    v_lshrrev_b32 v26, 3, v25
    v_mul_u32_u24 v26, 40960, v26
    v_add_u32 v13, v24, v26
    v_add_u32 v24, 128, v1
    v_mul_u32_u24 v25, 6554, v24
    v_lshrrev_b32 v25, 16, v25
    v_mul_u32_u24 v26, 1120, v25
    v_lshl_add_u32 v24, v24, 4, v26
    v_lshrrev_b32 v26, 4, v25
    v_mul_u32_u24 v26, 10240, v26
    v_add_u32 v6, v24, v26
    v_lshrrev_b32 v26, 3, v25
    v_mul_u32_u24 v26, 40960, v26
    v_add_u32 v14, v24, v26
    v_add_u32 v24, 192, v1
    v_mul_u32_u24 v25, 6554, v24
    v_lshrrev_b32 v25, 16, v25
    v_mul_u32_u24 v26, 1120, v25
    v_lshl_add_u32 v24, v24, 4, v26
    v_lshrrev_b32 v26, 4, v25
    v_mul_u32_u24 v26, 10240, v26
    v_add_u32 v7, v24, v26
    v_lshrrev_b32 v26, 3, v25
    v_mul_u32_u24 v26, 40960, v26
    v_add_u32 v15, v24, v26
    v_add_u32 v24, 256, v1
    v_mul_u32_u24 v25, 6554, v24
    v_lshrrev_b32 v25, 16, v25
    v_mul_u32_u24 v26, 1120, v25
    v_lshl_add_u32 v24, v24, 4, v26
    v_lshrrev_b32 v26, 4, v25
    v_mul_u32_u24 v26, 10240, v26
    v_add_u32 v8, v24, v26
    v_lshrrev_b32 v26, 3, v25
    v_mul_u32_u24 v26, 40960, v26
    v_add_u32 v16, v24, v26
    s_mov_b32 s36, s8
    s_mov_b32 s37, s9
    s_mov_b32 s38, 0xc8000
    s_mov_b32 s39, 0x20000
    s_add_u32 s44, s24, 0x780000
    s_addc_u32 s45, s25, 0
    s_mov_b32 s46, 0xc8000
    s_mov_b32 s47, 0x20000
    s_and_b32 s52, s27, 7
    s_mul_i32 s54, s52, 160
    s_mul_i32 s53, s26, 204800
    s_add_u32 s54, s54, s53
    s_lshl_b32 s52, s52, 2
    s_add_u32 s52, s52, s26
    s_mul_i32 s55, s52, 25600
    s_bitcmp1_b32 s27, 3
    s_cbranch_scc1 L_h1_27
    s_add_u32 s52, s54, 0
    buffer_load_dwordx4 v[104:107], v4, s[36:39], s52 offen
    buffer_load_dwordx4 v[108:111], v5, s[36:39], s52 offen
    buffer_load_dwordx4 v[112:115], v6, s[36:39], s52 offen
    buffer_load_dwordx4 v[116:119], v7, s[36:39], s52 offen
    buffer_load_dwordx4 v[120:123], v8, s[36:39], s52 offen
    s_add_u32 s52, s54, 51200
    buffer_load_dwordx4 v[124:127], v4, s[36:39], s52 offen
    buffer_load_dwordx4 v[128:131], v5, s[36:39], s52 offen
    buffer_load_dwordx4 v[132:135], v6, s[36:39], s52 offen
    buffer_load_dwordx4 v[136:139], v7, s[36:39], s52 offen
    buffer_load_dwordx4 v[140:143], v8, s[36:39], s52 offen
    s_add_u32 s52, s54, 102400
    buffer_load_dwordx4 v[144:147], v4, s[36:39], s52 offen
    buffer_load_dwordx4 v[148:151], v5, s[36:39], s52 offen
    buffer_load_dwordx4 v[152:155], v6, s[36:39], s52 offen
    buffer_load_dwordx4 v[156:159], v7, s[36:39], s52 offen
    buffer_load_dwordx4 v[160:163], v8, s[36:39], s52 offen
    s_waitcnt vmcnt(0)
    s_add_u32 s52, s55, 0
    s_add_u32 s53, s52, 4096
    buffer_store_dwordx4 v[104:107], v199, s[44:47], s52 offen offset:0 sc1
    buffer_store_dwordx4 v[108:111], v199, s[44:47], s52 offen offset:1024 sc1
    buffer_store_dwordx4 v[112:115], v199, s[44:47], s52 offen offset:2048 sc1
    buffer_store_dwordx4 v[116:119], v199, s[44:47], s52 offen offset:3072 sc1
    buffer_store_dwordx4 v[120:123], v199, s[44:47], s53 offen offset:0 sc1
    s_add_u32 s52, s55, 5120
    s_add_u32 s53, s52, 4096
    buffer_store_dwordx4 v[124:127], v199, s[44:47], s52 offen offset:0 sc1
    buffer_store_dwordx4 v[128:131], v199, s[44:47], s52 offen offset:1024 sc1
    buffer_store_dwordx4 v[132:135], v199, s[44:47], s52 offen offset:2048 sc1
    buffer_store_dwordx4 v[136:139], v199, s[44:47], s52 offen offset:3072 sc1
    buffer_store_dwordx4 v[140:143], v199, s[44:47], s53 offen offset:0 sc1
    s_add_u32 s52, s55, 10240
    s_add_u32 s53, s52, 4096
    buffer_store_dwordx4 v[144:147], v199, s[44:47], s52 offen offset:0 sc1
    buffer_store_dwordx4 v[148:151], v199, s[44:47], s52 offen offset:1024 sc1
    buffer_store_dwordx4 v[152:155], v199, s[44:47], s52 offen offset:2048 sc1
    buffer_store_dwordx4 v[156:159], v199, s[44:47], s52 offen offset:3072 sc1
    buffer_store_dwordx4 v[160:163], v199, s[44:47], s53 offen offset:0 sc1
    s_branch L_hd_28
L_h1_27:
    s_add_u32 s52, s54, 153600
    buffer_load_dwordx4 v[104:107], v4, s[36:39], s52 offen
    buffer_load_dwordx4 v[108:111], v5, s[36:39], s52 offen
    buffer_load_dwordx4 v[112:115], v6, s[36:39], s52 offen
    buffer_load_dwordx4 v[116:119], v7, s[36:39], s52 offen
    buffer_load_dwordx4 v[120:123], v8, s[36:39], s52 offen
    s_add_u32 s52, s54, 20480
    buffer_load_dwordx4 v[124:127], v12, s[36:39], s52 offen
    buffer_load_dwordx4 v[128:131], v13, s[36:39], s52 offen
    buffer_load_dwordx4 v[132:135], v14, s[36:39], s52 offen
    buffer_load_dwordx4 v[136:139], v15, s[36:39], s52 offen
    buffer_load_dwordx4 v[140:143], v16, s[36:39], s52 offen
    s_waitcnt vmcnt(0)
    s_add_u32 s52, s55, 15360
    s_add_u32 s53, s52, 4096
    buffer_store_dwordx4 v[104:107], v199, s[44:47], s52 offen offset:0 sc1
    buffer_store_dwordx4 v[108:111], v199, s[44:47], s52 offen offset:1024 sc1
    buffer_store_dwordx4 v[112:115], v199, s[44:47], s52 offen offset:2048 sc1
    buffer_store_dwordx4 v[116:119], v199, s[44:47], s52 offen offset:3072 sc1
    buffer_store_dwordx4 v[120:123], v199, s[44:47], s53 offen offset:0 sc1
    s_add_u32 s52, s55, 20480
    s_add_u32 s53, s52, 4096
    buffer_store_dwordx4 v[124:127], v199, s[44:47], s52 offen offset:0 sc1
    buffer_store_dwordx4 v[128:131], v199, s[44:47], s52 offen offset:1024 sc1
    buffer_store_dwordx4 v[132:135], v199, s[44:47], s52 offen offset:2048 sc1
    buffer_store_dwordx4 v[136:139], v199, s[44:47], s52 offen offset:3072 sc1
    buffer_store_dwordx4 v[140:143], v199, s[44:47], s53 offen offset:0 sc1
L_hd_28:
    s_and_b32 s52, s27, 7
    s_lshl_b32 s52, s52, 5
    s_bfe_u32 s53, s27, 0x10003
    s_add_u32 s52, s52, s53
    s_add_u32 s52, s52, 27
    s_lshl_b32 s52, s52, 7
    s_waitcnt vmcnt(0)
    s_barrier
    s_cmp_lg_u32 s26, 0
    s_cbranch_scc1 L_wf_26
    v_mov_b32 v196, 0
    v_mov_b32 v204, s28
    v_mov_b32 v205, s29
    s_mov_b64 exec, 1
    buffer_store_dwordx2 v[204:205], v196, s[48:51], s52 offen sc1
    s_mov_b64 exec, -1
L_wf_26:
    s_mov_b32 s32, s16
    s_mov_b32 s33, s17
    s_mov_b32 s34, 0x6c0000
    s_mov_b32 s35, 0x20000
    s_sub_u32 s52, s27, 216
    s_lshl_b32 s52, s52, 2
    s_add_u32 s52, s52, s26
    s_lshl_b32 s54, s52, 13
    s_mov_b32 s56, 9
L_pf_29:
    buffer_load_dword v198, v197, s[32:35], s54 offen
    s_add_u32 s54, s54, 786432
    s_sub_u32 s56, s56, 1
    s_cmp_lg_u32 s56, 0
    s_waitcnt vmcnt(0)
    s_cbranch_scc1 L_pf_29
L_both_21:
    v_mov_b32 v196, 0
    s_cmp_lg_u32 s26, 0
    s_cbranch_scc1 L_ow_30
    s_mov_b32 s56, 262144
L_poll_31:
    buffer_load_dwordx2 v[204:205], v196, s[48:51], 0 offen offset:0 sc1
    s_waitcnt vmcnt(0)
    v_cmpx_eq_u64 vcc, s[28:29], v[204:205]
    s_sub_u32 s56, s56, 1
    s_cmp_eq_u64 vcc, -1
    s_mov_b64 exec, -1
    s_cbranch_scc1 L_pout_32
    s_sleep 24
    s_cmp_lg_u32 s56, 0
    s_cbranch_scc1 L_poll_31
L_pout_32:
L_ow_30:
    s_barrier
L_second_13:
    s_mov_b32 s32, s16
    s_mov_b32 s33, s17
    s_mov_b32 s34, 0x6c0000
    s_mov_b32 s35, 0x20000
    s_mul_i32 s54, s26, 131072
    s_lshl_b32 s52, s60, 7
    s_add_u32 s54, s54, s52
    s_mul_i32 s55, s26, 40960
    s_mul_i32 s53, s61, 1280
    s_add_u32 s55, s55, s53
    s_add_u32 m0, s57, 0
    s_nop 0
    buffer_load_dwordx4 v232, s[32:35], s54 offen offset:0 lds
    buffer_load_dwordx4 v233, s[32:35], s54 offen offset:1024 lds
    buffer_load_dwordx4 v234, s[32:35], s54 offen offset:2048 lds
    buffer_load_dwordx4 v235, s[32:35], s54 offen offset:3072 lds
    s_add_u32 s54, s54, 524288
    s_add_u32 m0, s57, 5120
    s_nop 0
    buffer_load_dwordx4 v232, s[32:35], s54 offen offset:0 lds
    buffer_load_dwordx4 v233, s[32:35], s54 offen offset:1024 lds
    buffer_load_dwordx4 v234, s[32:35], s54 offen offset:2048 lds
    buffer_load_dwordx4 v235, s[32:35], s54 offen offset:3072 lds
    s_add_u32 s54, s54, 524288
    s_add_u32 m0, s57, 10240
    s_nop 0
    buffer_load_dwordx4 v232, s[32:35], s54 offen offset:0 lds
    buffer_load_dwordx4 v233, s[32:35], s54 offen offset:1024 lds
    buffer_load_dwordx4 v234, s[32:35], s54 offen offset:2048 lds
    buffer_load_dwordx4 v235, s[32:35], s54 offen offset:3072 lds
    s_add_u32 s54, s54, 524288
    s_add_u32 s36, s24, 0x780000
    s_addc_u32 s37, s25, 0
    s_mov_b32 s38, 0xc8000
    s_mov_b32 s39, 0x20000
    s_mov_b32 s44, s20
    s_mov_b32 s45, s21
    s_mov_b32 s46, 0x280000
    s_mov_b32 s47, 0x20000
    s_lshl_b32 s53, s61, 12
    s_cmp_lg_u32 s26, 0
    s_cbranch_scc1 L_ow_33
    s_mov_b32 s56, 262144
L_poll_34:
    buffer_load_dwordx2 v[204:205], v236, s[48:51], s53 offen offset:0 sc1
    s_waitcnt vmcnt(0)
    v_cmpx_eq_u64 vcc, s[28:29], v[204:205]
    s_sub_u32 s56, s56, 1
    s_cmp_eq_u64 vcc, -1
    s_mov_b64 exec, -1
    s_cbranch_scc1 L_pout_35
    s_sleep 4
    s_cmp_lg_u32 s56, 0
    s_cbranch_scc1 L_poll_34
L_pout_35:
L_ow_33:
    s_barrier
    s_setprio 1
    buffer_load_dwordx4 v[104:107], v192, s[40:43], s55 offen offset:0 sc1
    buffer_load_dwordx4 v[108:111], v192, s[40:43], s55 offen offset:256 sc1
    buffer_load_dwordx4 v[112:115], v192, s[40:43], s55 offen offset:512 sc1
    buffer_load_dwordx4 v[116:119], v192, s[40:43], s55 offen offset:768 sc1
    buffer_load_dwordx4 v[120:123], v192, s[40:43], s55 offen offset:1024 sc1
    s_add_u32 s55, s55, 163840
    buffer_load_dwordx4 v[124:127], v192, s[40:43], s55 offen offset:0 sc1
    buffer_load_dwordx4 v[128:131], v192, s[40:43], s55 offen offset:256 sc1
    buffer_load_dwordx4 v[132:135], v192, s[40:43], s55 offen offset:512 sc1
    buffer_load_dwordx4 v[136:139], v192, s[40:43], s55 offen offset:768 sc1
    buffer_load_dwordx4 v[140:143], v192, s[40:43], s55 offen offset:1024 sc1
    s_add_u32 s55, s55, 163840
    buffer_load_dwordx4 v[144:147], v192, s[40:43], s55 offen offset:0 sc1
    buffer_load_dwordx4 v[148:151], v192, s[40:43], s55 offen offset:256 sc1
    buffer_load_dwordx4 v[152:155], v192, s[40:43], s55 offen offset:512 sc1
    buffer_load_dwordx4 v[156:159], v192, s[40:43], s55 offen offset:768 sc1
    buffer_load_dwordx4 v[160:163], v192, s[40:43], s55 offen offset:1024 sc1
    s_add_u32 s55, s55, 163840
    s_waitcnt vmcnt(5)
    ds_read_b64_tr_b16 v[84:85], v184 offset:0
    ds_read_b64_tr_b16 v[86:87], v184 offset:512
    ds_read_b64_tr_b16 v[88:89], v185 offset:0
    ds_read_b64_tr_b16 v[90:91], v185 offset:512
    ds_read_b64_tr_b16 v[92:93], v186 offset:0
    ds_read_b64_tr_b16 v[94:95], v186 offset:512
    ds_read_b64_tr_b16 v[96:97], v187 offset:0
    ds_read_b64_tr_b16 v[98:99], v187 offset:512
    s_waitcnt vmcnt(18)
    s_waitcnt lgkmcnt(6)
    v_mfma_f32_16x16x32_bf16 v[4:7], v[104:107], v[84:87], 0
    v_mfma_f32_16x16x32_bf16 v[8:11], v[108:111], v[84:87], 0
    s_add_u32 m0, s57, 15360
    s_nop 0
    buffer_load_dwordx4 v232, s[32:35], s54 offen offset:0 lds
    v_mfma_f32_16x16x32_bf16 v[12:15], v[112:115], v[84:87], 0
    v_mfma_f32_16x16x32_bf16 v[16:19], v[116:119], v[84:87], 0
    buffer_load_dwordx4 v233, s[32:35], s54 offen offset:1024 lds
    v_mfma_f32_16x16x32_bf16 v[20:23], v[120:123], v[84:87], 0
    s_waitcnt vmcnt(16)
    ds_read_b64_tr_b16 v[84:85], v184 offset:5120
    ds_read_b64_tr_b16 v[86:87], v184 offset:5632
    s_waitcnt lgkmcnt(6)
    v_mfma_f32_16x16x32_bf16 v[24:27], v[104:107], v[88:91], 0
    buffer_load_dwordx4 v234, s[32:35], s54 offen offset:2048 lds
    v_mfma_f32_16x16x32_bf16 v[28:31], v[108:111], v[88:91], 0
    buffer_load_dwordx4 v235, s[32:35], s54 offen offset:3072 lds
    v_mfma_f32_16x16x32_bf16 v[32:35], v[112:115], v[88:91], 0
    v_mfma_f32_16x16x32_bf16 v[36:39], v[116:119], v[88:91], 0
    s_add_u32 s54, s54, 524288
    buffer_load_dwordx4 v[164:167], v192, s[40:43], s55 offen offset:0 sc1
    v_mfma_f32_16x16x32_bf16 v[40:43], v[120:123], v[88:91], 0
    ds_read_b64_tr_b16 v[88:89], v185 offset:5120
    ds_read_b64_tr_b16 v[90:91], v185 offset:5632
    s_waitcnt lgkmcnt(6)
    v_mfma_f32_16x16x32_bf16 v[44:47], v[104:107], v[92:95], 0
    buffer_load_dwordx4 v[168:171], v192, s[40:43], s55 offen offset:256 sc1
    v_mfma_f32_16x16x32_bf16 v[48:51], v[108:111], v[92:95], 0
    buffer_load_dwordx4 v[172:175], v192, s[40:43], s55 offen offset:512 sc1
    v_mfma_f32_16x16x32_bf16 v[52:55], v[112:115], v[92:95], 0
    v_mfma_f32_16x16x32_bf16 v[56:59], v[116:119], v[92:95], 0
    buffer_load_dwordx4 v[176:179], v192, s[40:43], s55 offen offset:768 sc1
    v_mfma_f32_16x16x32_bf16 v[60:63], v[120:123], v[92:95], 0
    ds_read_b64_tr_b16 v[92:93], v186 offset:5120
    ds_read_b64_tr_b16 v[94:95], v186 offset:5632
    s_waitcnt lgkmcnt(6)
    v_mfma_f32_16x16x32_bf16 v[64:67], v[104:107], v[96:99], 0
    buffer_load_dwordx4 v[180:183], v192, s[40:43], s55 offen offset:1024 sc1
    v_mfma_f32_16x16x32_bf16 v[68:71], v[108:111], v[96:99], 0
    s_add_u32 s55, s55, 163840
    v_mfma_f32_16x16x32_bf16 v[72:75], v[112:115], v[96:99], 0
    v_mfma_f32_16x16x32_bf16 v[76:79], v[116:119], v[96:99], 0
    v_mfma_f32_16x16x32_bf16 v[80:83], v[120:123], v[96:99], 0
    ds_read_b64_tr_b16 v[96:97], v187 offset:5120
    ds_read_b64_tr_b16 v[98:99], v187 offset:5632
    s_mov_b32 s56, 10
.p2align 6
L_gl_36:
    s_waitcnt vmcnt(18)
    s_waitcnt lgkmcnt(6)
    v_mfma_f32_16x16x32_bf16 v[4:7], v[124:127], v[84:87], v[4:7]
    v_mfma_f32_16x16x32_bf16 v[8:11], v[128:131], v[84:87], v[8:11]
    s_add_u32 m0, s57, 0
    s_nop 0
    buffer_load_dwordx4 v232, s[32:35], s54 offen offset:0 lds
    v_mfma_f32_16x16x32_bf16 v[12:15], v[132:135], v[84:87], v[12:15]
    v_mfma_f32_16x16x32_bf16 v[16:19], v[136:139], v[84:87], v[16:19]
    buffer_load_dwordx4 v233, s[32:35], s54 offen offset:1024 lds
    v_mfma_f32_16x16x32_bf16 v[20:23], v[140:143], v[84:87], v[20:23]
    s_waitcnt vmcnt(16)
    ds_read_b64_tr_b16 v[84:85], v184 offset:10240
    ds_read_b64_tr_b16 v[86:87], v184 offset:10752
    s_waitcnt lgkmcnt(6)
    v_mfma_f32_16x16x32_bf16 v[24:27], v[124:127], v[88:91], v[24:27]
    buffer_load_dwordx4 v234, s[32:35], s54 offen offset:2048 lds
    v_mfma_f32_16x16x32_bf16 v[28:31], v[128:131], v[88:91], v[28:31]
    buffer_load_dwordx4 v235, s[32:35], s54 offen offset:3072 lds
    v_mfma_f32_16x16x32_bf16 v[32:35], v[132:135], v[88:91], v[32:35]
    v_mfma_f32_16x16x32_bf16 v[36:39], v[136:139], v[88:91], v[36:39]
    s_add_u32 s54, s54, 524288
    buffer_load_dwordx4 v[104:107], v192, s[40:43], s55 offen offset:0 sc1
    v_mfma_f32_16x16x32_bf16 v[40:43], v[140:143], v[88:91], v[40:43]
    ds_read_b64_tr_b16 v[88:89], v185 offset:10240
    ds_read_b64_tr_b16 v[90:91], v185 offset:10752
    s_waitcnt lgkmcnt(6)
    v_mfma_f32_16x16x32_bf16 v[44:47], v[124:127], v[92:95], v[44:47]
    buffer_load_dwordx4 v[108:111], v192, s[40:43], s55 offen offset:256 sc1
    v_mfma_f32_16x16x32_bf16 v[48:51], v[128:131], v[92:95], v[48:51]
    buffer_load_dwordx4 v[112:115], v192, s[40:43], s55 offen offset:512 sc1
    v_mfma_f32_16x16x32_bf16 v[52:55], v[132:135], v[92:95], v[52:55]
    v_mfma_f32_16x16x32_bf16 v[56:59], v[136:139], v[92:95], v[56:59]
    buffer_load_dwordx4 v[116:119], v192, s[40:43], s55 offen offset:768 sc1
    v_mfma_f32_16x16x32_bf16 v[60:63], v[140:143], v[92:95], v[60:63]
    ds_read_b64_tr_b16 v[92:93], v186 offset:10240
    ds_read_b64_tr_b16 v[94:95], v186 offset:10752
    s_waitcnt lgkmcnt(6)
    v_mfma_f32_16x16x32_bf16 v[64:67], v[124:127], v[96:99], v[64:67]
    buffer_load_dwordx4 v[120:123], v192, s[40:43], s55 offen offset:1024 sc1
    v_mfma_f32_16x16x32_bf16 v[68:71], v[128:131], v[96:99], v[68:71]
    s_add_u32 s55, s55, 163840
    v_mfma_f32_16x16x32_bf16 v[72:75], v[132:135], v[96:99], v[72:75]
    v_mfma_f32_16x16x32_bf16 v[76:79], v[136:139], v[96:99], v[76:79]
    v_mfma_f32_16x16x32_bf16 v[80:83], v[140:143], v[96:99], v[80:83]
    ds_read_b64_tr_b16 v[96:97], v187 offset:10240
    ds_read_b64_tr_b16 v[98:99], v187 offset:10752
    s_waitcnt vmcnt(18)
    s_waitcnt lgkmcnt(6)
    v_mfma_f32_16x16x32_bf16 v[4:7], v[144:147], v[84:87], v[4:7]
    v_mfma_f32_16x16x32_bf16 v[8:11], v[148:151], v[84:87], v[8:11]
    s_add_u32 m0, s57, 5120
    s_nop 0
    buffer_load_dwordx4 v232, s[32:35], s54 offen offset:0 lds
    v_mfma_f32_16x16x32_bf16 v[12:15], v[152:155], v[84:87], v[12:15]
    v_mfma_f32_16x16x32_bf16 v[16:19], v[156:159], v[84:87], v[16:19]
    buffer_load_dwordx4 v233, s[32:35], s54 offen offset:1024 lds
    v_mfma_f32_16x16x32_bf16 v[20:23], v[160:163], v[84:87], v[20:23]
    s_waitcnt vmcnt(16)
    ds_read_b64_tr_b16 v[84:85], v184 offset:15360
    ds_read_b64_tr_b16 v[86:87], v184 offset:15872
    s_waitcnt lgkmcnt(6)
    v_mfma_f32_16x16x32_bf16 v[24:27], v[144:147], v[88:91], v[24:27]
    buffer_load_dwordx4 v234, s[32:35], s54 offen offset:2048 lds
    v_mfma_f32_16x16x32_bf16 v[28:31], v[148:151], v[88:91], v[28:31]
    buffer_load_dwordx4 v235, s[32:35], s54 offen offset:3072 lds
    v_mfma_f32_16x16x32_bf16 v[32:35], v[152:155], v[88:91], v[32:35]
    v_mfma_f32_16x16x32_bf16 v[36:39], v[156:159], v[88:91], v[36:39]
    s_add_u32 s54, s54, 524288
    buffer_load_dwordx4 v[124:127], v192, s[40:43], s55 offen offset:0 sc1
    v_mfma_f32_16x16x32_bf16 v[40:43], v[160:163], v[88:91], v[40:43]
    ds_read_b64_tr_b16 v[88:89], v185 offset:15360
    ds_read_b64_tr_b16 v[90:91], v185 offset:15872
    s_waitcnt lgkmcnt(6)
    v_mfma_f32_16x16x32_bf16 v[44:47], v[144:147], v[92:95], v[44:47]
    buffer_load_dwordx4 v[128:131], v192, s[40:43], s55 offen offset:256 sc1
    v_mfma_f32_16x16x32_bf16 v[48:51], v[148:151], v[92:95], v[48:51]
    buffer_load_dwordx4 v[132:135], v192, s[40:43], s55 offen offset:512 sc1
    v_mfma_f32_16x16x32_bf16 v[52:55], v[152:155], v[92:95], v[52:55]
    v_mfma_f32_16x16x32_bf16 v[56:59], v[156:159], v[92:95], v[56:59]
    buffer_load_dwordx4 v[136:139], v192, s[40:43], s55 offen offset:768 sc1
    v_mfma_f32_16x16x32_bf16 v[60:63], v[160:163], v[92:95], v[60:63]
    ds_read_b64_tr_b16 v[92:93], v186 offset:15360
    ds_read_b64_tr_b16 v[94:95], v186 offset:15872
    s_waitcnt lgkmcnt(6)
    v_mfma_f32_16x16x32_bf16 v[64:67], v[144:147], v[96:99], v[64:67]
    buffer_load_dwordx4 v[140:143], v192, s[40:43], s55 offen offset:1024 sc1
    v_mfma_f32_16x16x32_bf16 v[68:71], v[148:151], v[96:99], v[68:71]
    s_add_u32 s55, s55, 163840
    v_mfma_f32_16x16x32_bf16 v[72:75], v[152:155], v[96:99], v[72:75]
    v_mfma_f32_16x16x32_bf16 v[76:79], v[156:159], v[96:99], v[76:79]
    v_mfma_f32_16x16x32_bf16 v[80:83], v[160:163], v[96:99], v[80:83]
    ds_read_b64_tr_b16 v[96:97], v187 offset:15360
    ds_read_b64_tr_b16 v[98:99], v187 offset:15872
    s_sub_u32 s56, s56, 2
    s_cmp_eq_u32 s56, 0
    s_cbranch_scc1 L_gd_37
    s_waitcnt vmcnt(18)
    s_waitcnt lgkmcnt(6)
    v_mfma_f32_16x16x32_bf16 v[4:7], v[164:167], v[84:87], v[4:7]
    v_mfma_f32_16x16x32_bf16 v[8:11], v[168:171], v[84:87], v[8:11]
    s_add_u32 m0, s57, 10240
    s_nop 0
    buffer_load_dwordx4 v232, s[32:35], s54 offen offset:0 lds
    v_mfma_f32_16x16x32_bf16 v[12:15], v[172:175], v[84:87], v[12:15]
    v_mfma_f32_16x16x32_bf16 v[16:19], v[176:179], v[84:87], v[16:19]
    buffer_load_dwordx4 v233, s[32:35], s54 offen offset:1024 lds
    v_mfma_f32_16x16x32_bf16 v[20:23], v[180:183], v[84:87], v[20:23]
    s_waitcnt vmcnt(16)
    ds_read_b64_tr_b16 v[84:85], v184 offset:0
    ds_read_b64_tr_b16 v[86:87], v184 offset:512
    s_waitcnt lgkmcnt(6)
    v_mfma_f32_16x16x32_bf16 v[24:27], v[164:167], v[88:91], v[24:27]
    buffer_load_dwordx4 v234, s[32:35], s54 offen offset:2048 lds
    v_mfma_f32_16x16x32_bf16 v[28:31], v[168:171], v[88:91], v[28:31]
    buffer_load_dwordx4 v235, s[32:35], s54 offen offset:3072 lds
    v_mfma_f32_16x16x32_bf16 v[32:35], v[172:175], v[88:91], v[32:35]
    v_mfma_f32_16x16x32_bf16 v[36:39], v[176:179], v[88:91], v[36:39]
    s_add_u32 s54, s54, 524288
    buffer_load_dwordx4 v[144:147], v192, s[40:43], s55 offen offset:0 sc1
    v_mfma_f32_16x16x32_bf16 v[40:43], v[180:183], v[88:91], v[40:43]
    ds_read_b64_tr_b16 v[88:89], v185 offset:0
    ds_read_b64_tr_b16 v[90:91], v185 offset:512
    s_waitcnt lgkmcnt(6)
    v_mfma_f32_16x16x32_bf16 v[44:47], v[164:167], v[92:95], v[44:47]
    buffer_load_dwordx4 v[148:151], v192, s[40:43], s55 offen offset:256 sc1
    v_mfma_f32_16x16x32_bf16 v[48:51], v[168:171], v[92:95], v[48:51]
    buffer_load_dwordx4 v[152:155], v192, s[40:43], s55 offen offset:512 sc1
    v_mfma_f32_16x16x32_bf16 v[52:55], v[172:175], v[92:95], v[52:55]
    v_mfma_f32_16x16x32_bf16 v[56:59], v[176:179], v[92:95], v[56:59]
    buffer_load_dwordx4 v[156:159], v192, s[40:43], s55 offen offset:768 sc1
    v_mfma_f32_16x16x32_bf16 v[60:63], v[180:183], v[92:95], v[60:63]
    ds_read_b64_tr_b16 v[92:93], v186 offset:0
    ds_read_b64_tr_b16 v[94:95], v186 offset:512
    s_waitcnt lgkmcnt(6)
    v_mfma_f32_16x16x32_bf16 v[64:67], v[164:167], v[96:99], v[64:67]
    buffer_load_dwordx4 v[160:163], v192, s[40:43], s55 offen offset:1024 sc1
    v_mfma_f32_16x16x32_bf16 v[68:71], v[168:171], v[96:99], v[68:71]
    s_add_u32 s55, s55, 163840
    v_mfma_f32_16x16x32_bf16 v[72:75], v[172:175], v[96:99], v[72:75]
    v_mfma_f32_16x16x32_bf16 v[76:79], v[176:179], v[96:99], v[76:79]
    v_mfma_f32_16x16x32_bf16 v[80:83], v[180:183], v[96:99], v[80:83]
    ds_read_b64_tr_b16 v[96:97], v187 offset:0
    ds_read_b64_tr_b16 v[98:99], v187 offset:512
    s_waitcnt vmcnt(18)
    s_waitcnt lgkmcnt(6)
    v_mfma_f32_16x16x32_bf16 v[4:7], v[104:107], v[84:87], v[4:7]
    v_mfma_f32_16x16x32_bf16 v[8:11], v[108:111], v[84:87], v[8:11]
    s_add_u32 m0, s57, 15360
    s_nop 0
    buffer_load_dwordx4 v232, s[32:35], s54 offen offset:0 lds
    v_mfma_f32_16x16x32_bf16 v[12:15], v[112:115], v[84:87], v[12:15]
    v_mfma_f32_16x16x32_bf16 v[16:19], v[116:119], v[84:87], v[16:19]
    buffer_load_dwordx4 v233, s[32:35], s54 offen offset:1024 lds
    v_mfma_f32_16x16x32_bf16 v[20:23], v[120:123], v[84:87], v[20:23]
    s_waitcnt vmcnt(16)
    ds_read_b64_tr_b16 v[84:85], v184 offset:5120
    ds_read_b64_tr_b16 v[86:87], v184 offset:5632
    s_waitcnt lgkmcnt(6)
    v_mfma_f32_16x16x32_bf16 v[24:27], v[104:107], v[88:91], v[24:27]
    buffer_load_dwordx4 v234, s[32:35], s54 offen offset:2048 lds
    v_mfma_f32_16x16x32_bf16 v[28:31], v[108:111], v[88:91], v[28:31]
    buffer_load_dwordx4 v235, s[32:35], s54 offen offset:3072 lds
    v_mfma_f32_16x16x32_bf16 v[32:35], v[112:115], v[88:91], v[32:35]
    v_mfma_f32_16x16x32_bf16 v[36:39], v[116:119], v[88:91], v[36:39]
    s_add_u32 s54, s54, 524288
    buffer_load_dwordx4 v[164:167], v192, s[40:43], s55 offen offset:0 sc1
    v_mfma_f32_16x16x32_bf16 v[40:43], v[120:123], v[88:91], v[40:43]
    ds_read_b64_tr_b16 v[88:89], v185 offset:5120
    ds_read_b64_tr_b16 v[90:91], v185 offset:5632
    s_waitcnt lgkmcnt(6)
    v_mfma_f32_16x16x32_bf16 v[44:47], v[104:107], v[92:95], v[44:47]
    buffer_load_dwordx4 v[168:171], v192, s[40:43], s55 offen offset:256 sc1
    v_mfma_f32_16x16x32_bf16 v[48:51], v[108:111], v[92:95], v[48:51]
    buffer_load_dwordx4 v[172:175], v192, s[40:43], s55 offen offset:512 sc1
    v_mfma_f32_16x16x32_bf16 v[52:55], v[112:115], v[92:95], v[52:55]
    v_mfma_f32_16x16x32_bf16 v[56:59], v[116:119], v[92:95], v[56:59]
    buffer_load_dwordx4 v[176:179], v192, s[40:43], s55 offen offset:768 sc1
    v_mfma_f32_16x16x32_bf16 v[60:63], v[120:123], v[92:95], v[60:63]
    ds_read_b64_tr_b16 v[92:93], v186 offset:5120
    ds_read_b64_tr_b16 v[94:95], v186 offset:5632
    s_waitcnt lgkmcnt(6)
    v_mfma_f32_16x16x32_bf16 v[64:67], v[104:107], v[96:99], v[64:67]
    buffer_load_dwordx4 v[180:183], v192, s[40:43], s55 offen offset:1024 sc1
    v_mfma_f32_16x16x32_bf16 v[68:71], v[108:111], v[96:99], v[68:71]
    s_add_u32 s55, s55, 163840
    v_mfma_f32_16x16x32_bf16 v[72:75], v[112:115], v[96:99], v[72:75]
    v_mfma_f32_16x16x32_bf16 v[76:79], v[116:119], v[96:99], v[76:79]
    v_mfma_f32_16x16x32_bf16 v[80:83], v[120:123], v[96:99], v[80:83]
    ds_read_b64_tr_b16 v[96:97], v187 offset:5120
    ds_read_b64_tr_b16 v[98:99], v187 offset:5632
    s_sub_u32 s56, s56, 2
    s_cmp_eq_u32 s56, 0
    s_cbranch_scc0 L_gl_36
L_gd_37:
    s_waitcnt vmcnt(18) lgkmcnt(0)
    v_mfma_f32_16x16x32_bf16 v[4:7], v[164:167], v[84:87], v[4:7]
    v_mfma_f32_16x16x32_bf16 v[8:11], v[168:171], v[84:87], v[8:11]
    s_add_u32 m0, s57, 10240
    s_add_u32 s64, s63, 4096
    buffer_load_dwordx4 v199, s[36:39], s63 offen offset:0 sc1 lds
    v_mfma_f32_16x16x32_bf16 v[12:15], v[172:175], v[84:87], v[12:15]
    v_mfma_f32_16x16x32_bf16 v[16:19], v[176:179], v[84:87], v[16:19]
    buffer_load_dwordx4 v199, s[36:39], s63 offen offset:1024 sc1 lds
    v_mfma_f32_16x16x32_bf16 v[20:23], v[180:183], v[84:87], v[20:23]
    s_waitcnt vmcnt(16)
    ds_read_b64_tr_b16 v[84:85], v184 offset:0
    ds_read_b64_tr_b16 v[86:87], v184 offset:512
    v_mfma_f32_16x16x32_bf16 v[24:27], v[164:167], v[88:91], v[24:27]
    buffer_load_dwordx4 v199, s[36:39], s63 offen offset:2048 sc1 lds
    v_mfma_f32_16x16x32_bf16 v[28:31], v[168:171], v[88:91], v[28:31]
    buffer_load_dwordx4 v199, s[36:39], s63 offen offset:3072 sc1 lds
    v_mfma_f32_16x16x32_bf16 v[32:35], v[172:175], v[88:91], v[32:35]
    v_mfma_f32_16x16x32_bf16 v[36:39], v[176:179], v[88:91], v[36:39]
    s_add_u32 m0, s57, 14336
    s_add_u32 s63, s63, 5120
    buffer_load_dwordx4 v199, s[36:39], s64 offen sc1 lds
    v_mfma_f32_16x16x32_bf16 v[40:43], v[180:183], v[88:91], v[40:43]
    ds_read_b64_tr_b16 v[88:89], v185 offset:0
    ds_read_b64_tr_b16 v[90:91], v185 offset:512
    v_mfma_f32_16x16x32_bf16 v[44:47], v[164:167], v[92:95], v[44:47]
    s_add_u32 m0, s57, 15360
    s_add_u32 s64, s63, 4096
    buffer_load_dwordx4 v199, s[36:39], s63 offen offset:0 sc1 lds
    v_mfma_f32_16x16x32_bf16 v[48:51], v[168:171], v[92:95], v[48:51]
    buffer_load_dwordx4 v199, s[36:39], s63 offen offset:1024 sc1 lds
    v_mfma_f32_16x16x32_bf16 v[52:55], v[172:175], v[92:95], v[52:55]
    v_mfma_f32_16x16x32_bf16 v[56:59], v[176:179], v[92:95], v[56:59]
    buffer_load_dwordx4 v199, s[36:39], s63 offen offset:2048 sc1 lds
    v_mfma_f32_16x16x32_bf16 v[60:63], v[180:183], v[92:95], v[60:63]
    ds_read_b64_tr_b16 v[92:93], v186 offset:0
    ds_read_b64_tr_b16 v[94:95], v186 offset:512
    v_mfma_f32_16x16x32_bf16 v[64:67], v[164:167], v[96:99], v[64:67]
    buffer_load_dwordx4 v199, s[36:39], s63 offen offset:3072 sc1 lds
    v_mfma_f32_16x16x32_bf16 v[68:71], v[168:171], v[96:99], v[68:71]
    s_add_u32 m0, s57, 19456
    s_add_u32 s63, s63, 5120
    buffer_load_dwordx4 v199, s[36:39], s64 offen sc1 lds
    v_mfma_f32_16x16x32_bf16 v[72:75], v[172:175], v[96:99], v[72:75]
    v_mfma_f32_16x16x32_bf16 v[76:79], v[176:179], v[96:99], v[76:79]
    v_mfma_f32_16x16x32_bf16 v[80:83], v[180:183], v[96:99], v[80:83]
    ds_read_b64_tr_b16 v[96:97], v187 offset:0
    ds_read_b64_tr_b16 v[98:99], v187 offset:512
    s_mov_b32 s32, s4
    s_mov_b32 s33, s5
    s_mov_b32 s34, 0x280000
    s_mov_b32 s35, 0x20000
    s_waitcnt vmcnt(19) lgkmcnt(0)
    v_mfma_f32_16x16x32_bf16 v[4:7], v[104:107], v[84:87], v[4:7]
    v_mfma_f32_16x16x32_bf16 v[8:11], v[108:111], v[84:87], v[8:11]
    s_add_u32 m0, s57, 0
    s_add_u32 s64, s63, 4096
    buffer_load_dwordx4 v199, s[36:39], s63 offen offset:0 sc1 lds
    v_mfma_f32_16x16x32_bf16 v[12:15], v[112:115], v[84:87], v[12:15]
    v_mfma_f32_16x16x32_bf16 v[16:19], v[116:119], v[84:87], v[16:19]
    buffer_load_dwordx4 v199, s[36:39], s63 offen offset:1024 sc1 lds
    v_mfma_f32_16x16x32_bf16 v[20:23], v[120:123], v[84:87], v[20:23]
    s_waitcnt vmcnt(17)
    ds_read_b64_tr_b16 v[84:85], v184 offset:5120
    ds_read_b64_tr_b16 v[86:87], v184 offset:5632
    v_mfma_f32_16x16x32_bf16 v[24:27], v[104:107], v[88:91], v[24:27]
    buffer_load_dwordx4 v199, s[36:39], s63 offen offset:2048 sc1 lds
    v_mfma_f32_16x16x32_bf16 v[28:31], v[108:111], v[88:91], v[28:31]
    buffer_load_dwordx4 v199, s[36:39], s63 offen offset:3072 sc1 lds
    v_mfma_f32_16x16x32_bf16 v[32:35], v[112:115], v[88:91], v[32:35]
    v_mfma_f32_16x16x32_bf16 v[36:39], v[116:119], v[88:91], v[36:39]
    s_add_u32 m0, s57, 4096
    s_add_u32 s63, s63, 5120
    buffer_load_dwordx4 v199, s[36:39], s64 offen sc1 lds
    v_mfma_f32_16x16x32_bf16 v[40:43], v[120:123], v[88:91], v[40:43]
    ds_read_b64_tr_b16 v[88:89], v185 offset:5120
    ds_read_b64_tr_b16 v[90:91], v185 offset:5632
    v_mfma_f32_16x16x32_bf16 v[44:47], v[104:107], v[92:95], v[44:47]
    buffer_load_dwordx4 v[216:219], v229, s[32:35], s62 offen offset:0
    v_mfma_f32_16x16x32_bf16 v[48:51], v[108:111], v[92:95], v[48:51]
    buffer_load_dwordx4 v[220:223], v229, s[32:35], s62 offen offset:64
    v_mfma_f32_16x16x32_bf16 v[52:55], v[112:115], v[92:95], v[52:55]
    v_mfma_f32_16x16x32_bf16 v[56:59], v[116:119], v[92:95], v[56:59]
    buffer_load_dwordx4 v[224:227], v230, s[32:35], s62 offen offset:128
    v_mfma_f32_16x16x32_bf16 v[60:63], v[120:123], v[92:95], v[60:63]
    ds_read_b64_tr_b16 v[92:93], v186 offset:5120
    ds_read_b64_tr_b16 v[94:95], v186 offset:5632
    v_mfma_f32_16x16x32_bf16 v[64:67], v[104:107], v[96:99], v[64:67]
    v_mfma_f32_16x16x32_bf16 v[68:71], v[108:111], v[96:99], v[68:71]
    v_mfma_f32_16x16x32_bf16 v[72:75], v[112:115], v[96:99], v[72:75]
    v_mfma_f32_16x16x32_bf16 v[76:79], v[116:119], v[96:99], v[76:79]
    v_mfma_f32_16x16x32_bf16 v[80:83], v[120:123], v[96:99], v[80:83]
    ds_read_b64_tr_b16 v[96:97], v187 offset:5120
    ds_read_b64_tr_b16 v[98:99], v187 offset:5632
    s_waitcnt vmcnt(18) lgkmcnt(0)
    v_mfma_f32_16x16x32_bf16 v[4:7], v[124:127], v[84:87], v[4:7]
    v_mfma_f32_16x16x32_bf16 v[8:11], v[128:131], v[84:87], v[8:11]
    buffer_load_dwordx2 v[204:205], v242, s[48:51], s70 offen sc1
    v_mfma_f32_16x16x32_bf16 v[12:15], v[132:135], v[84:87], v[12:15]
    v_mfma_f32_16x16x32_bf16 v[16:19], v[136:139], v[84:87], v[16:19]
    s_add_u32 m0, s57, 5120
    s_add_u32 s64, s63, 4096
    buffer_load_dwordx4 v199, s[36:39], s63 offen offset:0 sc1 lds
    v_mfma_f32_16x16x32_bf16 v[20:23], v[140:143], v[84:87], v[20:23]
    s_waitcnt vmcnt(15)
    ds_read_b64_tr_b16 v[84:85], v231 offset:10240
    ds_read_b64_tr_b16 v[86:87], v231 offset:10880
    ds_read_b64_tr_b16 v[100:101], v231 offset:10368
    ds_read_b64_tr_b16 v[102:103], v231 offset:11008
    v_mfma_f32_16x16x32_bf16 v[24:27], v[124:127], v[88:91], v[24:27]
    buffer_load_dwordx4 v199, s[36:39], s63 offen offset:1024 sc1 lds
    v_mfma_f32_16x16x32_bf16 v[28:31], v[128:131], v[88:91], v[28:31]
    buffer_load_dwordx4 v199, s[36:39], s63 offen offset:2048 sc1 lds
    v_mfma_f32_16x16x32_bf16 v[32:35], v[132:135], v[88:91], v[32:35]
    v_mfma_f32_16x16x32_bf16 v[36:39], v[136:139], v[88:91], v[36:39]
    buffer_load_dwordx4 v199, s[36:39], s63 offen offset:3072 sc1 lds
    v_mfma_f32_16x16x32_bf16 v[40:43], v[140:143], v[88:91], v[40:43]
    ds_read_b64_tr_b16 v[88:89], v231 offset:10272
    ds_read_b64_tr_b16 v[90:91], v231 offset:10912
    v_mfma_f32_16x16x32_bf16 v[44:47], v[124:127], v[92:95], v[44:47]
    s_add_u32 m0, s57, 9216
    s_add_u32 s63, s63, 5120
    buffer_load_dwordx4 v199, s[36:39], s64 offen sc1 lds
    v_mfma_f32_16x16x32_bf16 v[48:51], v[128:131], v[92:95], v[48:51]
    v_mfma_f32_16x16x32_bf16 v[52:55], v[132:135], v[92:95], v[52:55]
    v_mfma_f32_16x16x32_bf16 v[56:59], v[136:139], v[92:95], v[56:59]
    v_mfma_f32_16x16x32_bf16 v[60:63], v[140:143], v[92:95], v[60:63]
    ds_read_b64_tr_b16 v[92:93], v231 offset:10304
    ds_read_b64_tr_b16 v[94:95], v231 offset:10944
    v_mfma_f32_16x16x32_bf16 v[64:67], v[124:127], v[96:99], v[64:67]
    v_mfma_f32_16x16x32_bf16 v[68:71], v[128:131], v[96:99], v[68:71]
    v_mfma_f32_16x16x32_bf16 v[72:75], v[132:135], v[96:99], v[72:75]
    v_mfma_f32_16x16x32_bf16 v[76:79], v[136:139], v[96:99], v[76:79]
    v_mfma_f32_16x16x32_bf16 v[80:83], v[140:143], v[96:99], v[80:83]
    ds_read_b64_tr_b16 v[96:97], v231 offset:10336
    ds_read_b64_tr_b16 v[98:99], v231 offset:10976
    s_setprio 3
    s_add_u32 s32, s24, 0xf00000
    s_addc_u32 s33, s25, 0
    s_mov_b32 s34, 0x280000
    s_mov_b32 s35, 0x20000
    s_waitcnt vmcnt(5)
    v_cmp_eq_u64 vcc, s[28:29], v[204:205]
    s_cmp_eq_u64 vcc, -1
    s_cbranch_scc1 L_join_39
    s_mov_b32 s56, 262144
L_poll_40:
    buffer_load_dwordx2 v[204:205], v242, s[48:51], s70 offen offset:0 sc1
    s_waitcnt vmcnt(0)
    v_cmpx_eq_u64 vcc, s[28:29], v[204:205]
    s_sub_u32 s56, s56, 1
    s_cmp_eq_u64 vcc, -1
    s_mov_b64 exec, -1
    s_cbranch_scc1 L_pout_41
    s_sleep 4
    s_cmp_lg_u32 s56, 0
    s_cbranch_scc1 L_poll_40
L_pout_41:
L_join_39:
    buffer_load_dwordx4 v[104:107], v243, s[32:35], s65 offen sc1
    s_add_u32 s65, s65, 131072
    buffer_load_dwordx4 v[108:111], v243, s[32:35], s66 offen sc1
    s_add_u32 s66, s66, 131072
    buffer_load_dwordx4 v[112:115], v243, s[32:35], s67 offen sc1
    s_add_u32 s67, s67, 131072
    buffer_load_dwordx4 v[116:119], v243, s[32:35], s68 offen sc1
    s_add_u32 s68, s68, 131072
    buffer_load_dwordx4 v[120:123], v243, s[32:35], s65 offen sc1
    s_add_u32 s65, s65, 131072
    buffer_load_dwordx4 v[124:127], v243, s[32:35], s66 offen sc1
    s_add_u32 s66, s66, 131072
    buffer_load_dwordx4 v[128:131], v243, s[32:35], s67 offen sc1
    s_add_u32 s67, s67, 131072
    buffer_load_dwordx4 v[132:135], v243, s[32:35], s68 offen sc1
    s_add_u32 s68, s68, 131072
    buffer_load_dwordx4 v[136:139], v243, s[32:35], s65 offen sc1
    s_add_u32 s65, s65, 131072
    buffer_load_dwordx4 v[140:143], v243, s[32:35], s66 offen sc1
    s_add_u32 s66, s66, 131072
    buffer_load_dwordx4 v[144:147], v243, s[32:35], s67 offen sc1
    s_add_u32 s67, s67, 131072
    buffer_load_dwordx4 v[148:151], v243, s[32:35], s68 offen sc1
    s_add_u32 s68, s68, 131072
    s_waitcnt lgkmcnt(0)
    s_add_u32 m0, s57, 10240
    s_add_u32 s64, s63, 4096
    buffer_load_dwordx4 v199, s[36:39], s63 offen offset:0 sc1 lds
    buffer_load_dwordx4 v199, s[36:39], s63 offen offset:1024 sc1 lds
    buffer_load_dwordx4 v199, s[36:39], s63 offen offset:2048 sc1 lds
    buffer_load_dwordx4 v199, s[36:39], s63 offen offset:3072 sc1 lds
    s_add_u32 m0, s57, 14336
    s_add_u32 s63, s63, 5120
    buffer_load_dwordx4 v199, s[36:39], s64 offen sc1 lds
    v_permlane16_swap_b32 v216, v218
    v_permlane16_swap_b32 v217, v219
    v_permlane16_swap_b32 v220, v222
    v_permlane16_swap_b32 v221, v223
    v_permlane16_swap_b32 v224, v226
    v_permlane16_swap_b32 v225, v227
    v_lshlrev_b32 v200, 16, v216
    v_and_b32 v201, 0xffff0000, v216
    v_lshlrev_b32 v202, 16, v217
    v_and_b32 v203, 0xffff0000, v217
    v_add_f32 v4, v4, v228
    v_add_f32 v5, v5, v228
    v_add_f32 v6, v6, v228
    v_add_f32 v7, v7, v228
    v_add_f32 v4, v4, v200
    v_add_f32 v5, v5, v201
    v_add_f32 v6, v6, v202
    v_add_f32 v7, v7, v203
    v_lshlrev_b32 v200, 16, v218
    v_and_b32 v201, 0xffff0000, v218
    v_lshlrev_b32 v202, 16, v219
    v_and_b32 v203, 0xffff0000, v219
    v_add_f32 v8, v8, v228
    v_add_f32 v9, v9, v228
    v_add_f32 v10, v10, v228
    v_add_f32 v11, v11, v228
    v_add_f32 v8, v8, v200
    v_add_f32 v9, v9, v201
    v_add_f32 v10, v10, v202
    v_add_f32 v11, v11, v203
    v_lshlrev_b32 v200, 16, v220
    v_and_b32 v201, 0xffff0000, v220
    v_lshlrev_b32 v202, 16, v221
    v_and_b32 v203, 0xffff0000, v221
    v_add_f32 v12, v12, v228
    v_add_f32 v13, v13, v228
    v_add_f32 v14, v14, v228
    v_add_f32 v15, v15, v228
    v_add_f32 v12, v12, v200
    v_add_f32 v13, v13, v201
    v_add_f32 v14, v14, v202
    v_add_f32 v15, v15, v203
    v_lshlrev_b32 v200, 16, v222
    v_and_b32 v201, 0xffff0000, v222
    v_lshlrev_b32 v202, 16, v223
    v_and_b32 v203, 0xffff0000, v223
    v_add_f32 v16, v16, v228
    v_add_f32 v17, v17, v228
    v_add_f32 v18, v18, v228
    v_add_f32 v19, v19, v228
    v_add_f32 v16, v16, v200
    v_add_f32 v17, v17, v201
    v_add_f32 v18, v18, v202
    v_add_f32 v19, v19, v203
    v_lshlrev_b32 v200, 16, v224
    v_and_b32 v201, 0xffff0000, v224
    v_lshlrev_b32 v202, 16, v225
    v_and_b32 v203, 0xffff0000, v225
    v_add_f32 v20, v20, v228
    v_add_f32 v21, v21, v228
    v_add_f32 v22, v22, v228
    v_add_f32 v23, v23, v228
    v_add_f32 v20, v20, v200
    v_add_f32 v21, v21, v201
    v_add_f32 v22, v22, v202
    v_add_f32 v23, v23, v203
    s_waitcnt vmcnt(13)
    v_mfma_f32_16x16x32_bf16 v[24:27], v[84:87], v[108:111], v[24:27]
    buffer_load_dwordx4 v[152:155], v243, s[32:35], s65 offen sc1
    v_mfma_f32_16x16x32_bf16 v[44:47], v[84:87], v[112:115], v[44:47]
    v_mfma_f32_16x16x32_bf16 v[64:67], v[84:87], v[116:119], v[64:67]
    buffer_load_dwordx4 v[156:159], v243, s[32:35], s66 offen sc1
    v_mfma_f32_16x16x32_bf16 v[4:7], v[84:87], v[104:107], v[4:7]
    ds_read_b64_tr_b16 v[84:85], v231 offset:15360
    ds_read_b64_tr_b16 v[86:87], v231 offset:16000
    v_mfma_f32_16x16x32_bf16 v[28:31], v[88:91], v[108:111], v[28:31]
    buffer_load_dwordx4 v[160:163], v243, s[32:35], s67 offen sc1
    v_mfma_f32_16x16x32_bf16 v[48:51], v[88:91], v[112:115], v[48:51]
    v_mfma_f32_16x16x32_bf16 v[68:71], v[88:91], v[116:119], v[68:71]
    buffer_load_dwordx4 v[164:167], v243, s[32:35], s68 offen sc1
    v_mfma_f32_16x16x32_bf16 v[8:11], v[88:91], v[104:107], v[8:11]
    ds_read_b64_tr_b16 v[88:89], v231 offset:15392
    ds_read_b64_tr_b16 v[90:91], v231 offset:16032
    v_mfma_f32_16x16x32_bf16 v[32:35], v[92:95], v[108:111], v[32:35]
    v_mfma_f32_16x16x32_bf16 v[52:55], v[92:95], v[112:115], v[52:55]
    v_mfma_f32_16x16x32_bf16 v[72:75], v[92:95], v[116:119], v[72:75]
    v_mfma_f32_16x16x32_bf16 v[12:15], v[92:95], v[104:107], v[12:15]
    ds_read_b64_tr_b16 v[92:93], v231 offset:15424
    ds_read_b64_tr_b16 v[94:95], v231 offset:16064
    v_mfma_f32_16x16x32_bf16 v[36:39], v[96:99], v[108:111], v[36:39]
    v_mfma_f32_16x16x32_bf16 v[56:59], v[96:99], v[112:115], v[56:59]
    v_mfma_f32_16x16x32_bf16 v[76:79], v[96:99], v[116:119], v[76:79]
    v_mfma_f32_16x16x32_bf16 v[16:19], v[96:99], v[104:107], v[16:19]
    ds_read_b64_tr_b16 v[96:97], v231 offset:15456
    ds_read_b64_tr_b16 v[98:99], v231 offset:16096
    v_mfma_f32_16x16x32_bf16 v[40:43], v[100:103], v[108:111], v[40:43]
    v_mfma_f32_16x16x32_bf16 v[60:63], v[100:103], v[112:115], v[60:63]
    v_mfma_f32_16x16x32_bf16 v[80:83], v[100:103], v[116:119], v[80:83]
    v_mfma_f32_16x16x32_bf16 v[20:23], v[100:103], v[104:107], v[20:23]
    ds_read_b64_tr_b16 v[100:101], v231 offset:15488
    ds_read_b64_tr_b16 v[102:103], v231 offset:16128
    s_waitcnt vmcnt(13)
    s_waitcnt lgkmcnt(8)
    v_mfma_f32_16x16x32_bf16 v[24:27], v[84:87], v[124:127], v[24:27]
    s_xor_b32 s52, s26, 0
    s_lshl_b32 s52, s52, 7
    s_add_u32 s52, s52, s69
    s_add_u32 s53, s52, 16384
    buffer_load_dwordx2 v[168:169], v244, s[32:35], s52 offen sc1
    v_mfma_f32_16x16x32_bf16 v[44:47], v[84:87], v[128:131], v[44:47]
    v_mfma_f32_16x16x32_bf16 v[64:67], v[84:87], v[132:135], v[64:67]
    buffer_load_dwordx2 v[170:171], v244, s[32:35], s53 offen sc1
    v_mfma_f32_16x16x32_bf16 v[4:7], v[84:87], v[120:123], v[4:7]
    ds_read_b64_tr_b16 v[84:85], v231 offset:0
    ds_read_b64_tr_b16 v[86:87], v231 offset:640
    s_waitcnt lgkmcnt(8)
    v_mfma_f32_16x16x32_bf16 v[28:31], v[88:91], v[124:127], v[28:31]
    s_xor_b32 s52, s26, 1
    s_lshl_b32 s52, s52, 7
    s_add_u32 s52, s52, s69
    s_add_u32 s53, s52, 16384
    buffer_load_dwordx2 v[172:173], v244, s[32:35], s52 offen sc1
    v_mfma_f32_16x16x32_bf16 v[48:51], v[88:91], v[128:131], v[48:51]
    v_mfma_f32_16x16x32_bf16 v[68:71], v[88:91], v[132:135], v[68:71]
    buffer_load_dwordx2 v[174:175], v244, s[32:35], s53 offen sc1
    v_mfma_f32_16x16x32_bf16 v[8:11], v[88:91], v[120:123], v[8:11]
    ds_read_b64_tr_b16 v[88:89], v231 offset:32
    ds_read_b64_tr_b16 v[90:91], v231 offset:672
    s_waitcnt lgkmcnt(8)
    v_mfma_f32_16x16x32_bf16 v[32:35], v[92:95], v[124:127], v[32:35]
    s_xor_b32 s52, s26, 2
    s_lshl_b32 s52, s52, 7
    s_add_u32 s52, s52, s69
    s_add_u32 s53, s52, 16384
    buffer_load_dwordx2 v[176:177], v244, s[32:35], s52 offen sc1
    v_mfma_f32_16x16x32_bf16 v[52:55], v[92:95], v[128:131], v[52:55]
    v_mfma_f32_16x16x32_bf16 v[72:75], v[92:95], v[132:135], v[72:75]
    buffer_load_dwordx2 v[178:179], v244, s[32:35], s53 offen sc1
    v_mfma_f32_16x16x32_bf16 v[12:15], v[92:95], v[120:123], v[12:15]
    ds_read_b64_tr_b16 v[92:93], v231 offset:64
    ds_read_b64_tr_b16 v[94:95], v231 offset:704
    s_waitcnt lgkmcnt(8)
    v_mfma_f32_16x16x32_bf16 v[36:39], v[96:99], v[124:127], v[36:39]
    s_xor_b32 s52, s26, 3
    s_lshl_b32 s52, s52, 7
    s_add_u32 s52, s52, s69
    s_add_u32 s53, s52, 16384
    buffer_load_dwordx2 v[180:181], v244, s[32:35], s52 offen sc1
    v_mfma_f32_16x16x32_bf16 v[56:59], v[96:99], v[128:131], v[56:59]
    v_mfma_f32_16x16x32_bf16 v[76:79], v[96:99], v[132:135], v[76:79]
    buffer_load_dwordx2 v[182:183], v244, s[32:35], s53 offen sc1
    v_mfma_f32_16x16x32_bf16 v[16:19], v[96:99], v[120:123], v[16:19]
    ds_read_b64_tr_b16 v[96:97], v231 offset:96
    ds_read_b64_tr_b16 v[98:99], v231 offset:736
    s_waitcnt lgkmcnt(8)
    v_mfma_f32_16x16x32_bf16 v[40:43], v[100:103], v[124:127], v[40:43]
    v_mfma_f32_16x16x32_bf16 v[60:63], v[100:103], v[128:131], v[60:63]
    v_mfma_f32_16x16x32_bf16 v[80:83], v[100:103], v[132:135], v[80:83]
    v_mfma_f32_16x16x32_bf16 v[20:23], v[100:103], v[120:123], v[20:23]
    ds_read_b64_tr_b16 v[100:101], v231 offset:128
    ds_read_b64_tr_b16 v[102:103], v231 offset:768
    s_waitcnt vmcnt(17)
    s_waitcnt lgkmcnt(8)
    v_mfma_f32_16x16x32_bf16 v[24:27], v[84:87], v[140:143], v[24:27]
    v_mfma_f32_16x16x32_bf16 v[44:47], v[84:87], v[144:147], v[44:47]
    v_mfma_f32_16x16x32_bf16 v[64:67], v[84:87], v[148:151], v[64:67]
    v_mfma_f32_16x16x32_bf16 v[4:7], v[84:87], v[136:139], v[4:7]
    ds_read_b64_tr_b16 v[84:85], v231 offset:5120
    ds_read_b64_tr_b16 v[86:87], v231 offset:5760
    s_waitcnt lgkmcnt(8)
    v_mfma_f32_16x16x32_bf16 v[28:31], v[88:91], v[140:143], v[28:31]
    v_mfma_f32_16x16x32_bf16 v[48:51], v[88:91], v[144:147], v[48:51]
    v_mfma_f32_16x16x32_bf16 v[68:71], v[88:91], v[148:151], v[68:71]
    v_mfma_f32_16x16x32_bf16 v[8:11], v[88:91], v[136:139], v[8:11]
    ds_read_b64_tr_b16 v[88:89], v231 offset:5152
    ds_read_b64_tr_b16 v[90:91], v231 offset:5792
    s_waitcnt lgkmcnt(8)
    v_mfma_f32_16x16x32_bf16 v[32:35], v[92:95], v[140:143], v[32:35]
    v_mfma_f32_16x16x32_bf16 v[52:55], v[92:95], v[144:147], v[52:55]
    v_mfma_f32_16x16x32_bf16 v[72:75], v[92:95], v[148:151], v[72:75]
    v_mfma_f32_16x16x32_bf16 v[12:15], v[92:95], v[136:139], v[12:15]
    ds_read_b64_tr_b16 v[92:93], v231 offset:5184
    ds_read_b64_tr_b16 v[94:95], v231 offset:5824
    s_waitcnt lgkmcnt(8)
    v_mfma_f32_16x16x32_bf16 v[36:39], v[96:99], v[140:143], v[36:39]
    v_mfma_f32_16x16x32_bf16 v[56:59], v[96:99], v[144:147], v[56:59]
    v_mfma_f32_16x16x32_bf16 v[76:79], v[96:99], v[148:151], v[76:79]
    v_mfma_f32_16x16x32_bf16 v[16:19], v[96:99], v[136:139], v[16:19]
    ds_read_b64_tr_b16 v[96:97], v231 offset:5216
    ds_read_b64_tr_b16 v[98:99], v231 offset:5856
    s_waitcnt lgkmcnt(8)
    v_mfma_f32_16x16x32_bf16 v[40:43], v[100:103], v[140:143], v[40:43]
    v_mfma_f32_16x16x32_bf16 v[60:63], v[100:103], v[144:147], v[60:63]
    v_mfma_f32_16x16x32_bf16 v[80:83], v[100:103], v[148:151], v[80:83]
    v_mfma_f32_16x16x32_bf16 v[20:23], v[100:103], v[136:139], v[20:23]
    ds_read_b64_tr_b16 v[100:101], v231 offset:5248
    ds_read_b64_tr_b16 v[102:103], v231 offset:5888
    s_waitcnt vmcnt(8)
    s_waitcnt lgkmcnt(8)
    v_mfma_f32_16x16x32_bf16 v[24:27], v[84:87], v[156:159], v[24:27]
    v_mfma_f32_16x16x32_bf16 v[44:47], v[84:87], v[160:163], v[44:47]
    v_mfma_f32_16x16x32_bf16 v[64:67], v[84:87], v[164:167], v[64:67]
    v_mfma_f32_16x16x32_bf16 v[4:7], v[84:87], v[152:155], v[4:7]
    ds_read_b64_tr_b16 v[84:85], v231 offset:10240
    ds_read_b64_tr_b16 v[86:87], v231 offset:10880
    s_waitcnt lgkmcnt(8)
    v_mfma_f32_16x16x32_bf16 v[28:31], v[88:91], v[156:159], v[28:31]
    v_mfma_f32_16x16x32_bf16 v[48:51], v[88:91], v[160:163], v[48:51]
    v_mfma_f32_16x16x32_bf16 v[68:71], v[88:91], v[164:167], v[68:71]
    v_mfma_f32_16x16x32_bf16 v[8:11], v[88:91], v[152:155], v[8:11]
    ds_read_b64_tr_b16 v[88:89], v231 offset:10272
    ds_read_b64_tr_b16 v[90:91], v231 offset:10912
    s_waitcnt lgkmcnt(8)
    v_mfma_f32_16x16x32_bf16 v[32:35], v[92:95], v[156:159], v[32:35]
    v_mfma_f32_16x16x32_bf16 v[52:55], v[92:95], v[160:163], v[52:55]
    v_mfma_f32_16x16x32_bf16 v[72:75], v[92:95], v[164:167], v[72:75]
    v_mfma_f32_16x16x32_bf16 v[12:15], v[92:95], v[152:155], v[12:15]
    ds_read_b64_tr_b16 v[92:93], v231 offset:10304
    ds_read_b64_tr_b16 v[94:95], v231 offset:10944
    s_waitcnt lgkmcnt(8)
    v_mfma_f32_16x16x32_bf16 v[36:39], v[96:99], v[156:159], v[36:39]
    v_mfma_f32_16x16x32_bf16 v[56:59], v[96:99], v[160:163], v[56:59]
    v_mfma_f32_16x16x32_bf16 v[76:79], v[96:99], v[164:167], v[76:79]
    v_mfma_f32_16x16x32_bf16 v[16:19], v[96:99], v[152:155], v[16:19]
    ds_read_b64_tr_b16 v[96:97], v231 offset:10336
    ds_read_b64_tr_b16 v[98:99], v231 offset:10976
    s_waitcnt lgkmcnt(8)
    v_mfma_f32_16x16x32_bf16 v[40:43], v[100:103], v[156:159], v[40:43]
    v_mfma_f32_16x16x32_bf16 v[60:63], v[100:103], v[160:163], v[60:63]
    v_mfma_f32_16x16x32_bf16 v[80:83], v[100:103], v[164:167], v[80:83]
    v_mfma_f32_16x16x32_bf16 v[20:23], v[100:103], v[152:155], v[20:23]
    ds_read_b64_tr_b16 v[100:101], v231 offset:10368
    ds_read_b64_tr_b16 v[102:103], v231 offset:11008
    s_waitcnt vmcnt(0)
    s_waitcnt lgkmcnt(8)
    v_mfma_f32_16x16x32_bf16 v[24:27], v[84:87], v[172:175], v[24:27]
    s_waitcnt lgkmcnt(6)
    v_mfma_f32_16x16x32_bf16 v[28:31], v[88:91], v[172:175], v[28:31]
    s_waitcnt lgkmcnt(4)
    v_mfma_f32_16x16x32_bf16 v[32:35], v[92:95], v[172:175], v[32:35]
    s_waitcnt lgkmcnt(2)
    v_mfma_f32_16x16x32_bf16 v[36:39], v[96:99], v[172:175], v[36:39]
    s_waitcnt lgkmcnt(0)
    v_mfma_f32_16x16x32_bf16 v[40:43], v[100:103], v[172:175], v[40:43]
    v_mfma_f32_16x16x32_bf16 v[44:47], v[84:87], v[176:179], v[44:47]
    v_mfma_f32_16x16x32_bf16 v[48:51], v[88:91], v[176:179], v[48:51]
    v_mfma_f32_16x16x32_bf16 v[52:55], v[92:95], v[176:179], v[52:55]
    v_mfma_f32_16x16x32_bf16 v[56:59], v[96:99], v[176:179], v[56:59]
    v_mfma_f32_16x16x32_bf16 v[60:63], v[100:103], v[176:179], v[60:63]
    v_mfma_f32_16x16x32_bf16 v[64:67], v[84:87], v[180:183], v[64:67]
    ds_write_b128 v237, v[24:27] offset:0
    v_mfma_f32_16x16x32_bf16 v[68:71], v[88:91], v[180:183], v[68:71]
    ds_write_b128 v237, v[28:31] offset:1024
    v_mfma_f32_16x16x32_bf16 v[72:75], v[92:95], v[180:183], v[72:75]
    ds_write_b128 v237, v[32:35] offset:2048
    v_mfma_f32_16x16x32_bf16 v[76:79], v[96:99], v[180:183], v[76:79]
    ds_write_b128 v237, v[36:39] offset:3072
    v_mfma_f32_16x16x32_bf16 v[80:83], v[100:103], v[180:183], v[80:83]
    ds_write_b128 v237, v[40:43] offset:4096
    v_mfma_f32_16x16x32_bf16 v[4:7], v[84:87], v[168:171], v[4:7]
    ds_write_b128 v237, v[44:47] offset:5120
    v_mfma_f32_16x16x32_bf16 v[8:11], v[88:91], v[168:171], v[8:11]
    ds_write_b128 v237, v[48:51] offset:6144
    v_mfma_f32_16x16x32_bf16 v[12:15], v[92:95], v[168:171], v[12:15]
    ds_write_b128 v237, v[52:55] offset:7168
    v_mfma_f32_16x16x32_bf16 v[16:19], v[96:99], v[168:171], v[16:19]
    ds_write_b128 v237, v[56:59] offset:8192
    v_mfma_f32_16x16x32_bf16 v[20:23], v[100:103], v[168:171], v[20:23]
    ds_write_b128 v237, v[60:63] offset:9216
    ds_write_b128 v237, v[64:67] offset:10240
    ds_write_b128 v237, v[68:71] offset:11264
    ds_write_b128 v237, v[72:75] offset:12288
    ds_write_b128 v237, v[76:79] offset:13312
    ds_write_b128 v237, v[80:83] offset:14336
    s_waitcnt lgkmcnt(0)
    s_barrier
    ds_read_b128 v[24:27], v238 offset:0
    ds_read_b128 v[44:47], v239 offset:5120
    ds_read_b128 v[64:67], v240 offset:10240
    ds_read_b128 v[28:31], v238 offset:1024
    ds_read_b128 v[48:51], v239 offset:6144
    ds_read_b128 v[68:71], v240 offset:11264
    ds_read_b128 v[32:35], v238 offset:2048
    ds_read_b128 v[52:55], v239 offset:7168
    ds_read_b128 v[72:75], v240 offset:12288
    ds_read_b128 v[36:39], v238 offset:3072
    ds_read_b128 v[56:59], v239 offset:8192
    ds_read_b128 v[76:79], v240 offset:13312
    ds_read_b128 v[40:43], v238 offset:4096
    ds_read_b128 v[60:63], v239 offset:9216
    ds_read_b128 v[80:83], v240 offset:14336
    s_waitcnt lgkmcnt(12)
    v_pk_add_f32 v[4:5], v[4:5], v[24:25]
    v_pk_add_f32 v[6:7], v[6:7], v[26:27]
    v_pk_add_f32 v[44:45], v[44:45], v[64:65]
    v_pk_add_f32 v[46:47], v[46:47], v[66:67]
    v_pk_add_f32 v[4:5], v[4:5], v[44:45]
    v_pk_add_f32 v[6:7], v[6:7], v[46:47]
    s_waitcnt lgkmcnt(9)
    v_pk_add_f32 v[8:9], v[8:9], v[28:29]
    v_pk_add_f32 v[10:11], v[10:11], v[30:31]
    v_pk_add_f32 v[48:49], v[48:49], v[68:69]
    v_pk_add_f32 v[50:51], v[50:51], v[70:71]
    v_pk_add_f32 v[8:9], v[8:9], v[48:49]
    v_pk_add_f32 v[10:11], v[10:11], v[50:51]
    s_waitcnt lgkmcnt(6)
    v_pk_add_f32 v[12:13], v[12:13], v[32:33]
    v_pk_add_f32 v[14:15], v[14:15], v[34:35]
    v_pk_add_f32 v[52:53], v[52:53], v[72:73]
    v_pk_add_f32 v[54:55], v[54:55], v[74:75]
    v_pk_add_f32 v[12:13], v[12:13], v[52:53]
    v_pk_add_f32 v[14:15], v[14:15], v[54:55]
    s_waitcnt lgkmcnt(3)
    v_pk_add_f32 v[16:17], v[16:17], v[36:37]
    v_pk_add_f32 v[18:19], v[18:19], v[38:39]
    v_pk_add_f32 v[56:57], v[56:57], v[76:77]
    v_pk_add_f32 v[58:59], v[58:59], v[78:79]
    v_pk_add_f32 v[16:17], v[16:17], v[56:57]
    v_pk_add_f32 v[18:19], v[18:19], v[58:59]
    s_waitcnt lgkmcnt(0)
    v_pk_add_f32 v[20:21], v[20:21], v[40:41]
    v_pk_add_f32 v[22:23], v[22:23], v[42:43]
    v_pk_add_f32 v[60:61], v[60:61], v[80:81]
    v_pk_add_f32 v[62:63], v[62:63], v[82:83]
    v_pk_add_f32 v[20:21], v[20:21], v[60:61]
    v_pk_add_f32 v[22:23], v[22:23], v[62:63]
    v_cvt_pk_bf16_f32 v204, v4, v5
    v_cvt_pk_bf16_f32 v205, v6, v7
    v_cvt_pk_bf16_f32 v206, v8, v9
    v_cvt_pk_bf16_f32 v207, v10, v11
    v_cvt_pk_bf16_f32 v208, v12, v13
    v_cvt_pk_bf16_f32 v209, v14, v15
    v_cvt_pk_bf16_f32 v210, v16, v17
    v_cvt_pk_bf16_f32 v211, v18, v19
    v_cvt_pk_bf16_f32 v212, v20, v21
    v_cvt_pk_bf16_f32 v213, v22, v23
    v_mov_b32 v214, v212
    v_mov_b32 v215, v213
    v_permlane16_swap_b32 v204, v206
    v_permlane16_swap_b32 v205, v207
    v_permlane16_swap_b32 v208, v210
    v_permlane16_swap_b32 v209, v211
    v_permlane16_swap_b32 v212, v214
    v_permlane16_swap_b32 v213, v215
    buffer_store_dwordx4 v[204:207], v229, s[44:47], s62 offen
    buffer_store_dwordx4 v[208:211], v229, s[44:47], s62 offen offset:64
    s_mov_b32 exec_lo, 0xffff
    s_mov_b32 exec_hi, 0xffff
    buffer_store_dwordx4 v[212:215], v229, s[44:47], s62 offen offset:128
    s_endpgm
L_end_1:
    s_endpgm
L_code_end:
.set CODE_BYTES, L_code_end-parallel_sum__mha_block__mixer_token_mlp__prompt_kernel
.section .rodata,"a"
.p2align 6
.amdhsa_kernel parallel_sum__mha_block__mixer_token_mlp__prompt_kernel
  .amdhsa_next_free_vgpr 256
  .amdhsa_next_free_sgpr 71
  .amdhsa_accum_offset 256
  .amdhsa_group_segment_fixed_size 0
  .amdhsa_kernarg_size 88
  .amdhsa_user_sgpr_count 2
  .amdhsa_user_sgpr_kernarg_segment_ptr 1
  .amdhsa_system_sgpr_workgroup_id_x 1
.end_amdhsa_kernel
```
